```python
import torch

def _softmax(x, axis=-1):
    return torch.softmax(x, dim=axis)
def _gelu(x):
    return torch.nn.functional.gelu(x, approximate="tanh")
def _silu(x):
    return torch.nn.functional.silu(x)
def _sigmoid(x):
    return torch.sigmoid(x)
def _layernorm(x, axis=-1, eps=1e-5):
    m = x.mean(dim=axis, keepdim=True)
    v = x.var(dim=axis, keepdim=True, unbiased=False)
    return (x - m) / torch.sqrt(v + eps)
def _scatter_add(tgt, idx, src, axis=0):
    return tgt.clone().index_add_(axis, idx, src)
def _segment_sum(src, seg, n):
    out = torch.zeros((n,) + src.shape[1:], dtype=src.dtype)
    return out.index_add_(0, seg, src)
def _pad(x, pw):
    flat = tuple(v for pair in reversed(pw) for v in pair)
    return torch.nn.functional.pad(x, flat)

kernel_name = 'sequential_preLN__sliding_local_dilated__geglu_ffn__prompt'

def setup_inputs():

    _w = (lambda a: (lambda t: t.to(torch.bfloat16) if t.is_floating_point() else t)(torch.as_tensor(a)))
    def _A_setup():
        B, S, D = 1, 2048, 512
        return {
            "x": _w((lambda *s: torch.randn(*s, dtype=torch.bfloat16) * 0.05)(B, S, D)),
            "wqkv": _w((lambda *s: torch.randn(*s, dtype=torch.bfloat16) * 0.05)(D, 3 * D)),
            "wo": _w((lambda *s: torch.randn(*s, dtype=torch.bfloat16) * 0.05)(D, D)),
        }
    _A_in = _A_setup()

    def _B_setup():
        B, S, D, F = 1, 2048, 512, 1376
        return {
            "x": _w((lambda *s: torch.randn(*s, dtype=torch.bfloat16) * 0.05)(B, S, D)),
            "w_gate": _w((lambda *s: torch.randn(*s, dtype=torch.bfloat16) * 0.05)(D, F)),
            "w_up": _w((lambda *s: torch.randn(*s, dtype=torch.bfloat16) * 0.05)(D, F)),
            "w_down": _w((lambda *s: torch.randn(*s, dtype=torch.bfloat16) * 0.05)(F, D)),
        }
    _B_in = _B_setup()

    return {
        "A_x": _A_in["x"],
        "A_wqkv": _A_in["wqkv"],
        "A_wo": _A_in["wo"],
        "B_x": _B_in["x"],
        "B_w_gate": _B_in["w_gate"],
        "B_w_up": _B_in["w_up"],
        "B_w_down": _B_in["w_down"],
    }

def reference(A_x, A_wqkv, A_wo, B_x, B_w_gate, B_w_up, B_w_down):
    def _A_ref(x, wqkv, wo):
        B, S, D = x.shape
        H = 32; Dh = D // H
        W, dil = 8, 2
        qkv = (lambda x, *d: x.permute(*d))((x @ wqkv).reshape(B, S, 3, H, Dh), 2, 0, 3, 1, 4)
        q, k, v = qkv[0], qkv[1], qkv[2]
        scale = Dh ** -0.5
        pos = torch.arange(S)
        off = torch.arange(W) * dil
        idx = pos[:, None] - off[None, :]
        mask = idx >= 0
        idx_c = torch.where(mask, idx, 0).reshape(-1)
        kg = k[:, :, idx_c, :].reshape(B, H, S, W, Dh)
        vg = v[:, :, idx_c, :].reshape(B, H, S, W, Dh)
        logits = torch.einsum("bhsd,bhswd->bhsw", q, kg) * scale
        logits = torch.where(mask[None, None, :, :], logits, -1e9)
        attn = _softmax(logits, axis=-1)
        o = torch.einsum("bhsw,bhswd->bhsd", attn, vg)
        return (lambda x, *d: x.permute(*d))(o, 0, 2, 1, 3).reshape(B, S, D) @ wo

    def _B_ref(x, w_gate, w_up, w_down):
        return (_gelu(x @ w_gate) * (x @ w_up)) @ w_down

    x = A_x
    h = x + _A_ref(_layernorm(x, axis=-1), A_wqkv, A_wo)
    h2 = h + _B_ref(_layernorm(h, axis=-1), B_w_gate, B_w_up, B_w_down)
    return h2
```

```asm
; @launch grid=(256,1,1) block=(256,1,1) lds=163840
.amdgcn_target "amdgcn-amd-amdhsa--gfx950"
.set SPIN_MAX, 400000
.set CODE_SPAN, 28928
.text
.globl sequential_preLN__sliding_local_dilated__geglu_ffn__prompt_kernel
.p2align 12
.p2align 8
.type sequential_preLN__sliding_local_dilated__geglu_ffn__prompt_kernel,@function
sequential_preLN__sliding_local_dilated__geglu_ffn__prompt_kernel:
    s_load_dwordx2 s[4:5], s[0:1], 0
    s_load_dwordx2 s[8:9], s[0:1], 8
    s_load_dwordx4 s[44:47], s[0:1], 64
    s_load_dwordx2 s[12:13], s[0:1], 16
    s_load_dwordx8 s[36:43], s[0:1], 32
    s_cmp_ge_u32 s2, 256
    s_cbranch_scc1 L_end
    v_lshrrev_b32 v1, 6, v0
    v_and_b32 v0, 63, v0
    v_readfirstlane_b32 s3, v1
    s_lshr_b32 s73, s2, 3
    s_getpc_b64 s[56:57]
    s_lshl2_add_u32 s74, s73, s3
    s_lshl_b32 s74, s74, 8
    v_lshl_add_u32 v1, v0, 7, s74
    v_min_u32 v1, CODE_SPAN, v1
    s_mov_b64 exec, 3
    global_load_dword v6, v1, s[56:57] offset:768
    s_mov_b64 exec, -1
    s_and_b32 s68, s73, 15
    s_and_b32 s67, s73, 7
    s_lshr_b32 s73, s73, 3
    s_and_b32 s74, s2, 7
    s_lshl2_add_u32 s71, s74, s73
    s_lshr_b32 s70, s71, 1
    s_lshl_b32 s71, s71, 6
    s_lshl_b32 s66, s3, 10
    s_mov_b32 s6, 2097152
    s_mov_b32 s7, 0x20000
    s_mov_b32 s10, 1572864
    s_mov_b32 s11, 0x20000
    s_and_b32 s80, s3, 1
    s_lshr_b32 s81, s3, 1
    v_lshrrev_b32 v1, 3, v0
    v_lshrrev_b32 v5, 4, v0
    s_lshl_b32 s73, s80, 2
    v_xor_b32 v3, v0, v5
    v_and_b32 v3, 7, v3
    v_xor_b32 v3, s73, v3
    v_lshlrev_b32 v3, 4, v3
    s_lshl4_add_u32 s73, s80, s71
    v_lshl_add_u32 v4, v1, 1, s73
    v_lshl_add_u32 v7, v4, 10, v3
    v_add_u32 v8, 32768, v7
    s_add_u32 s73, s71, s80
    s_sub_u32 s73, s73, 16
    v_lshl_add_u32 v4, v1, 1, s73
    v_max_i32 v4, 0, v4
    v_lshl_add_u32 v9, v4, 10, v3
    s_lshl_b32 s73, s3, 3
    v_add_u32 v2, s73, v1
    s_lshl_b32 s73, s67, 7
    v_lshl_add_u32 v11, v2, 10, s73
    v_mul_u32_u24 v2, 43, v2
    v_bfe_u32 v3, v2, 8, 1
    v_bfe_u32 v4, v2, 10, 1
    v_lshl_add_u32 v3, v4, 1, v3
    v_lshlrev_b32 v3, 1, v3
    v_bitop3_b32 v3, v3, v0, 7 bitop3:0x28
    v_lshl_add_u32 v10, v3, 4, v11
    v_add_u32 v2, 1376, v2
    v_bfe_u32 v3, v2, 8, 1
    v_bfe_u32 v4, v2, 10, 1
    v_lshl_add_u32 v3, v4, 1, v3
    v_lshlrev_b32_e64 v3, 1, v3
    v_bitop3_b32 v3, v3, v0, 7 bitop3:0x28
    v_lshl_add_u32 v13, v3, 4, v11
    v_add_u32 v13, 32768, v13
    v_add_u32 v2, 1376, v2
    v_bfe_u32 v3, v2, 8, 1
    v_bfe_u32 v4, v2, 10, 1
    v_lshl_add_u32 v3, v4, 1, v3
    v_lshlrev_b32_e64 v3, 1, v3
    v_bitop3_b32 v3, v3, v0, 7 bitop3:0x28
    v_lshl_add_u32 v14, v3, 4, v11
    v_add_u32 v14, 65536, v14
    s_cmp_eq_u32 s80, 0
    s_cselect_b32 s58, 0xffffff00, -1
    s_mov_b32 s59, -1
    s_add_u32 s83, s67, s2
    s_and_b32 s83, s83, 7
    s_add_u32 s73, s83, s81
    s_and_b32 s73, s73, 7
    s_lshl_b32 s75, s73, 7
    s_mul_i32 s48, s83, 196608
    s_lshr_b32 s73, s2, 3
    s_add_u32 s74, s73, 4
    s_lshr_b32 s74, s74, 3
    s_sub_u32 s73, s73, s74
    s_lshl2_add_u32 s73, s73, s3
    s_mul_i32 s73, s73, 14336
    s_cmp_eq_u32 s67, 3
    s_cselect_b32 s73, 2146435072, s73
    v_lshl_add_u32 v1, v0, 10, s73
    s_waitcnt lgkmcnt(0)
    s_mov_b64 exec, 0x3fff
    buffer_load_dword v6, v1, s[8:11], 0 offen offset:384
    s_mov_b64 exec, -1
    s_add_u32 m0, s66, 4096
    s_nop 0
    buffer_load_dwordx4 v7, s[4:7], s75 offen lds
    s_add_u32 m0, s66, 8192
    s_nop 0
    buffer_load_dwordx4 v8, s[4:7], s75 offen lds
    s_add_u32 m0, s66, 11264
    s_nop 0
    buffer_load_dwordx4 v7, s[4:7], s75 offen offset:1024 lds
    s_add_u32 m0, s66, 15360
    s_nop 0
    buffer_load_dwordx4 v8, s[4:7], s75 offen offset:1024 lds
    s_add_u32 m0, s66, 20480
    s_mov_b64 exec, s[58:59]
    buffer_load_dwordx4 v9, s[4:7], s75 offen lds
    s_mov_b64 exec, -1
    s_add_u32 s75, s75, 256
    s_and_b32 s75, s75, 0x3ff
    s_add_u32 m0, s66, 45056
    s_nop 0
    buffer_load_dwordx4 v10, s[8:11], s48 offen lds
    s_add_u32 m0, s66, 49152
    s_nop 0
    buffer_load_dwordx4 v13, s[8:11], s48 offen lds
    s_add_u32 m0, s66, 53248
    s_nop 0
    buffer_load_dwordx4 v14, s[8:11], s48 offen lds
    v_add_u32 v12, 98304, v10
    v_add_u32 v15, 98304, v13
    v_add_u32 v16, 98304, v14
    v_lshrrev_b32 v2, 3, v0
    v_and_b32 v3, 4, v2
    s_lshl2_add_u32 s73, s81, s80
    s_lshl_b32 s73, s73, 2
    v_add3_u32 v11, v3, v2, s73
    s_add_u32 s73, s83, 1
    s_and_b32 s73, s73, 7
    s_mul_i32 s49, s73, 196608
    s_add_u32 s73, s83, 2
    s_and_b32 s73, s73, 7
    s_mul_i32 s50, s73, 196608
    s_add_u32 s73, s83, 3
    s_and_b32 s73, s73, 7
    s_mul_i32 s51, s73, 196608
    s_add_u32 s73, s83, 4
    s_and_b32 s73, s73, 7
    s_mul_i32 s52, s73, 196608
    s_add_u32 s73, s83, 5
    s_and_b32 s73, s73, 7
    s_mul_i32 s53, s73, 196608
    s_add_u32 s73, s83, 6
    s_and_b32 s73, s73, 7
    s_mul_i32 s54, s73, 196608
    s_add_u32 s73, s83, 7
    s_and_b32 s73, s73, 7
    s_mul_i32 s55, s73, 196608
    s_add_u32 m0, s66, 57344
    s_nop 0
    buffer_load_dwordx4 v12, s[8:11], s48 offen lds
    s_add_u32 m0, s66, 61440
    s_nop 0
    buffer_load_dwordx4 v15, s[8:11], s48 offen lds
    s_add_u32 m0, s66, 65536
    s_nop 0
    buffer_load_dwordx4 v16, s[8:11], s48 offen lds
    v_lshlrev_b32 v17, 4, v0
    s_mov_b64 s[28:29], s[44:45]
    s_mov_b64 s[32:33], s[46:47]
    s_mov_b32 s34, 33554432
    s_mov_b32 s35, 0x20000
    s_mov_b32 s30, 256
    s_mov_b32 s31, 0x20000
    s_and_b32 s73, s70, 1
    s_mul_i32 s73, s73, 671744
    s_lshr_b32 s74, s70, 1
    s_lshl_b32 s74, s74, 21
    s_add_u32 s72, s73, s74
    s_lshr_b32 s69, s68, 3
    s_cmp_eq_u32 s68, 0
    s_cbranch_scc0 L_noclear_1
    v_mov_b32 v24, 0
    v_mov_b32 v25, 0
    v_mov_b32 v26, 0
    v_mov_b32 v27, 0
    s_add_u32 s73, s72, s66
    s_add_u32 s73, s73, 667648
    buffer_store_dwordx4 v[24:27], v17, s[32:35], s73 offen sc1
L_noclear_1:
    v_mov_b32 v20, 0x3f803f80
    v_mov_b32 v21, 0x3f803f80
    v_mov_b32 v22, 0x3f803f80
    v_mov_b32 v23, 0x3f803f80
    v_and_b32 v1, 0x70, v17
    v_bfe_u32 v2, v0, 3, 1
    v_and_b32_e64 v3, 1, v5
    v_lshl_add_u32 v1, v2, 11, v1
    v_mul_u32_u24 v3, 20480, v3
    v_add_u32 v4, v1, v3
    v_and_b32 v31, 15, v0
    v_lshrrev_b32 v1, 1, v31
    ds_write_b128 v4, v[20:23] offset:20480
    v_xor_b32 v1, v1, v5
    v_lshlrev_b32 v1, 4, v1
    v_lshl_add_u32 v18, v31, 7, v1
    v_xor_b32 v19, 64, v18
    v_mov_b32 v1, s3
    v_cmp_ne_u32 vcc, 0, v31
    v_and_b32 v3, 7, v0
    s_lshl2_add_u32 s73, s3, 62
    v_cndmask_b32 v2, 4, v1, vcc
    v_lshl_add_u32 v28, v2, 12, v18
    v_add_u32 v3, s73, v3
    v_lshlrev_b32_e64 v1, 4, v1
    s_mov_b32 vcc_lo, 0x3c3c3c3c
    s_mov_b32 vcc_hi, 0x3c3c3c3c
    v_cndmask_b32 v3, 64, v3, vcc
    s_mov_b32 vcc_lo, 0x02020202
    s_mov_b32 vcc_hi, 0x02020202
    v_cndmask_b32 v1, v3, v1, vcc
    v_lshlrev_b32 v34, 2, v1
    v_bfe_u32 v2, v1, 1, 3
    v_xor_b32 v2, v2, v5
    v_and_b32 v3, 0x70, v1
    v_add_u32 v1, v1, v3
    v_lshlrev_b32 v2, 4, v2
    v_lshl_add_u32 v33, v1, 7, v2
    v_xor_b32 v29, 64, v28
    v_and_b32 v1, 8, v0
    v_lshlrev_b32 v1, 3, v1
    v_xor_b32 v33, v1, v33
    v_bfe_u32 v1, v0, 2, 3
    v_lshrrev_b32 v2, 1, v1
    v_xor_b32 v2, s3, v2
    v_lshlrev_b32 v2, 5, v2
    v_lshl_add_u32 v2, v1, 7, v2
    v_and_b32 v3, 3, v0
    v_lshl_add_u32 v2, v3, 3, v2
    v_lshrrev_b32 v32, 5, v0
    v_lshl_add_u32 v30, v32, 11, v2
    v_bfe_u32 v1, v0, 2, 2
    v_lshl_add_u32 v1, v5, 3, v1
    v_mul_u32_u24 v1, 384, v1
    v_and_b32 v2, 0x7f, v30
    v_add_u32 v35, v1, v2
    v_add_u32 v36, 65536, v35
    s_cmp_eq_u32 s80, 0
    s_cselect_b64 s[16:17], s[36:37], s[38:39]
    s_mov_b64 s[20:21], s[40:41]
    s_mov_b64 s[24:25], s[42:43]
    s_mov_b32 s14, 524288
    s_mov_b32 s15, 0x20000
    s_mov_b32 s18, 1409024
    s_mov_b32 s19, 0x20000
    s_mov_b32 s22, 1409024
    s_mov_b32 s23, 0x20000
    s_mov_b32 s26, 2097152
    s_mov_b32 s27, 0x20000
    s_lshl2_add_u32 s73, s2, s3
    s_lshl_b32 s74, s73, 9
    v_lshl_add_u32 v27, v0, 7, s74
    s_lshl1_add_u32 s84, s83, s80
    s_lshl1_add_u32 s85, s69, s81
    s_lshl2_add_u32 s73, s67, s3
    s_lshl_b32 s74, s69, 7
    s_add_u32 s73, s73, s74
    s_lshl_b32 s73, s73, 9
    s_add_u32 s86, s73, s72
    s_lshl2_add_u32 s73, s69, s3
    s_lshl3_add_u32 s73, s73, s83
    s_lshl_b32 s74, s73, 11
    s_add_u32 s74, s74, s72
    s_add_u32 s87, s74, 131072
    s_lshl3_add_u32 s73, s85, s83
    s_lshl_b32 s74, s73, 7
    s_lshl2_add_u32 s74, s80, s74
    s_add_u32 s74, s74, s72
    s_add_u32 s88, s74, 655360
    s_lshl_b32 s73, s68, 7
    s_add_u32 s73, s73, s72
    s_add_u32 s89, s73, 663552
    v_and_b32 v1, 3, v0
    v_bfe_u32 v2, v0, 2, 2
    v_lshlrev_b32 v1, 7, v1
    v_lshl_add_u32 v1, v2, 14, v1
    v_add_u32 v1, s86, v1
    v_lshl_add_u32 v2, v31, 7, s87
    v_cmp_gt_u32 vcc, 16, v0
    s_nop 1
    v_cndmask_b32 v26, v2, v1, vcc
    v_writelane_b32 v26, s88, 32
    v_writelane_b32 v26, s89, 33
    s_cmp_eq_u32 s67, 3
    s_cselect_b32 s73, 2146435072, 0
    s_cselect_b32 s44, -1, 0xffff0000
    s_cselect_b32 s45, 3, 0
    v_add_u32 v38, s73, v26
    v_add_u32 v27, s73, v27
    s_lshl2_add_u32 s73, s68, s3
    s_lshl_b32 s73, s73, 13
    v_add_u32 v39, s73, v17
    s_mov_b64 exec, 0xf
    buffer_load_dword v6, v27, s[12:15], 0 offen
    s_mov_b64 exec, -1
    v_lshrrev_b32 v1, 1, v31
    v_xor_b32 v1, v32, v1
    v_and_b32 v2, 1, v5
    v_lshl_add_u32 v1, v1, 1, v2
    s_lshl_b32 s73, s3, 12
    v_lshl_add_u32 v2, v31, 7, s73
    v_lshl_add_u32 v40, v1, 3, v2
    v_xor_b32 v41, 32, v40
    v_xor_b32 v42, 64, v40
    v_xor_b32 v43, 0x60, v40
    s_add_u32 m0, s66, 69632
    s_nop 0
    buffer_load_dwordx4 v10, s[8:11], s49 offen lds
    s_add_u32 m0, s66, 73728
    s_nop 0
    buffer_load_dwordx4 v13, s[8:11], s49 offen lds
    s_add_u32 m0, s66, 77824
    s_nop 0
    buffer_load_dwordx4 v14, s[8:11], s49 offen lds
    s_add_u32 m0, s66, 81920
    s_nop 0
    buffer_load_dwordx4 v12, s[8:11], s49 offen lds
    s_add_u32 m0, s66, 86016
    s_nop 0
    buffer_load_dwordx4 v15, s[8:11], s49 offen lds
    s_mov_b64 exec, 0
    s_cmp_eq_u32 s3, 0
    s_cbranch_scc1 L_warm_0
    s_cmp_eq_u32 s3, 1
    s_cbranch_scc1 L_warm_1
    s_cmp_eq_u32 s3, 2
    s_cbranch_scc1 L_warm_2
    s_branch L_warm_3
L_warm_back:
    s_mov_b64 exec, -1
    s_waitcnt vmcnt(9) lgkmcnt(0)
    s_barrier
    ds_read_b128 a[148:151], v28 offset:4096
    ds_read_b64_tr_b16 a[156:157], v35 offset:45184
    ds_read_b128 a[144:147], v18 offset:20480
    ds_read_b64_tr_b16 a[158:159], v35 offset:46720
    ds_read_b128 a[128:131], v18 offset:4096
    ds_read_b64_tr_b16 a[152:153], v35 offset:45056
    ds_read_b128 a[132:135], v18 offset:8192
    ds_read_b64_tr_b16 a[154:155], v35 offset:46592
    ds_read_b128 a[136:139], v18 offset:12288
    ds_read_b64_tr_b16 a[160:161], v35 offset:45312
    ds_read_b128 a[140:143], v18 offset:16384
    ds_read_b64_tr_b16 a[162:163], v35 offset:46848
    ds_read_b128 a[208:211], v33 offset:4096
    s_waitcnt vmcnt(6) lgkmcnt(0)
    s_barrier
    v_mfma_f32_16x16x32_bf16 v[148:151], a[148:151], a[148:151], 0
    s_add_u32 m0, s66, 90112
    ds_read_b128 a[184:187], v29 offset:4096
    buffer_load_dwordx4 v16, s[8:11], s49 offen lds
    v_mfma_f32_16x16x32_bf16 v[152:155], a[208:211], a[208:211], 0
    s_add_u32 m0, s66, 24576
    ds_read_b64_tr_b16 a[192:193], v35 offset:57472
    buffer_load_dwordx4 v7, s[4:7], s75 offen lds
    v_mfma_f32_16x16x32_bf16 v[124:127], a[156:159], a[144:147], 0
    ds_read_b128 a[180:183], v19 offset:20480
    s_mul_i32 s73, s69, 7
    v_mfma_f32_16x16x32_bf16 v[108:111], a[156:159], a[128:131], 0
    s_add_u32 m0, s66, 28672
    ds_read_b64_tr_b16 a[194:195], v35 offset:59008
    buffer_load_dwordx4 v8, s[4:7], s75 offen lds
    v_mfma_f32_16x16x32_bf16 v[112:115], a[156:159], a[132:135], 0
    ds_read_b128 a[164:167], v19 offset:4096
    s_lshr_b32 s74, s83, 2
    v_mfma_f32_16x16x32_bf16 v[116:119], a[156:159], a[136:139], 0
    s_add_u32 m0, s66, 31744
    ds_read_b64_tr_b16 a[188:189], v35 offset:57344
    buffer_load_dwordx4 v7, s[4:7], s75 offen offset:1024 lds
    s_sub_u32 s74, s83, s74
    v_mfma_f32_16x16x32_bf16 v[120:123], a[156:159], a[140:143], 0
    ds_read_b128 a[168:171], v19 offset:8192
    s_add_u32 s73, s73, s74
    s_add_u32 s74, s69, 14
    v_mfma_f32_16x16x32_bf16 v[100:103], a[152:155], a[140:143], 0
    s_add_u32 m0, s66, 35840
    ds_read_b64_tr_b16 a[190:191], v35 offset:58880
    buffer_load_dwordx4 v8, s[4:7], s75 offen offset:1024 lds
    s_cmp_eq_u32 s83, 3
    s_cselect_b32 s90, s74, s73
    v_mfma_f32_16x16x32_bf16 v[96:99], a[152:155], a[136:139], 0
    s_add_u32 m0, s66, 40960
    ds_read_b128 a[172:175], v19 offset:12288
    s_mov_b64 exec, s[58:59]
    buffer_load_dwordx4 v9, s[4:7], s75 offen lds
    s_mov_b64 exec, -1
    v_mfma_f32_16x16x32_bf16 v[92:95], a[152:155], a[132:135], 0
    s_add_u32 s75, s75, 256
    s_and_b32 s75, s75, 0x3ff
    ds_read_b64_tr_b16 a[196:197], v35 offset:57600
    s_and_b32 s74, s70, 1
    s_mul_i32 s74, s74, 14
    v_mfma_f32_16x16x32_bf16 v[88:91], a[152:155], a[128:131], 0
    s_add_u32 m0, s66, 94208
    ds_read_b128 a[176:179], v19 offset:16384
    buffer_load_dwordx4 v10, s[8:11], s50 offen lds
    s_add_u32 s74, s74, s90
    v_mfma_f32_16x16x32_bf16 v[104:107], a[152:155], v[20:23], 0
    ds_read_b64_tr_b16 a[198:199], v35 offset:59136
    s_cmp_ge_u32 s90, 14
    s_cselect_b32 s74, 0x2000, s74
    v_mfma_f32_16x16x32_bf16 v[144:147], a[144:147], a[160:163], 0
    s_add_u32 m0, s66, 98304
    s_nop 0
    buffer_load_dwordx4 v13, s[8:11], s50 offen lds
    s_lshr_b32 s46, s70, 1
    s_lshl2_add_u32 s73, s74, s3
    v_mfma_f32_16x16x32_bf16 v[128:131], a[128:131], a[160:163], 0
    s_lshl3_add_u32 s73, s73, s46
    s_mul_i32 s73, s73, 1664
    v_lshl_add_u32 v24, v0, 7, s73
    v_mfma_f32_16x16x32_bf16 v[132:135], a[132:135], a[160:163], 0
    s_lshr_b32 s46, s70, 1
    s_lshl1_add_u32 s73, s74, s81
    s_lshl3_add_u32 s73, s73, s46
    v_mfma_f32_16x16x32_bf16 v[136:139], a[136:139], a[160:163], 0
    v_mfma_f32_16x16x32_bf16 v[140:143], a[140:143], a[160:163], 0
    s_waitcnt vmcnt(10) lgkmcnt(0)
    s_barrier
    s_or_b32 s79, s68, s3
    s_cbranch_scc1 L_nopub_2
    s_lshl_b32 s79, s70, 4
    s_mov_b64 exec, 1
    buffer_store_dword v20, off, s[28:31], s79 sc1
    s_mov_b64 exec, 0xfffff
    s_add_u32 s79, s72, 667648
    v_lshl_add_u32 v85, v0, 7, s79
    buffer_load_dword v6, v85, s[32:35], 0 offen sc1
    s_mov_b64 exec, -1
L_nopub_2:
    v_mfma_f32_16x16x32_bf16 v[148:151], a[184:187], a[184:187], v[148:151]
    s_add_u32 m0, s66, 102400
    ds_read_b128 a[148:151], v28 offset:6144
    buffer_load_dwordx4 v14, s[8:11], s50 offen lds
    ds_read_b64_tr_b16 a[156:157], v36 offset:4224
    v_mfma_f32_16x16x32_bf16 v[124:127], a[192:195], a[180:183], v[124:127]
    s_add_u32 m0, s66, 106496
    ds_read_b128 a[144:147], v18 offset:22528
    buffer_load_dwordx4 v12, s[8:11], s50 offen lds
    v_mfma_f32_16x16x32_bf16 v[108:111], a[192:195], a[164:167], v[108:111]
    ds_read_b64_tr_b16 a[158:159], v36 offset:5760
    s_mul_i32 s73, s73, 3200
    v_lshl_add_u32 v25, v0, 7, s73
    v_mfma_f32_16x16x32_bf16 v[112:115], a[192:195], a[168:171], v[112:115]
    s_add_u32 m0, s66, 110592
    ds_read_b128 a[128:131], v18 offset:6144
    buffer_load_dwordx4 v15, s[8:11], s50 offen lds
    v_lshlrev_b32 v3, 1, v5
    v_mfma_f32_16x16x32_bf16 v[116:119], a[192:195], a[172:175], v[116:119]
    s_add_u32 m0, s66, 114688
    ds_read_b64_tr_b16 a[152:153], v36 offset:4096
    buffer_load_dwordx4 v16, s[8:11], s50 offen lds
    v_xor_b32_e64 v3, v3, v0
    v_mfma_f32_16x16x32_bf16 v[120:123], a[192:195], a[176:179], v[120:123]
    ds_read_b128 a[132:135], v18 offset:10240
    v_and_b32 v2, 7, v3
    s_lshl_b32 s73, s83, 7
    v_mfma_f32_16x16x32_bf16 v[100:103], a[188:191], a[176:179], v[100:103]
    s_add_u32 m0, s66, 118784
    ds_read_b64_tr_b16 a[154:155], v36 offset:5632
    buffer_load_dwordx4 v10, s[8:11], s51 offen lds
    v_lshl_add_u32 v2, v2, 4, s73
    v_mfma_f32_16x16x32_bf16 v[96:99], a[188:191], a[172:175], v[96:99]
    ds_read_b128 a[136:139], v18 offset:14336
    v_lshl_add_u32 v44, v11, 10, v2
    v_lshrrev_b32 v4, 3, v0
    v_mfma_f32_16x16x32_bf16 v[92:95], a[188:191], a[168:171], v[92:95]
    s_add_u32 m0, s66, 122880
    ds_read_b64_tr_b16 a[160:161], v36 offset:4352
    buffer_load_dwordx4 v13, s[8:11], s51 offen lds
    s_mul_i32 s73, s81, 96
    v_mfma_f32_16x16x32_bf16 v[88:91], a[188:191], a[164:167], v[88:91]
    s_add_u32 m0, s66, 126976
    ds_read_b128 a[140:143], v18 offset:18432
    buffer_load_dwordx4 v14, s[8:11], s51 offen lds
    s_lshl3_add_u32 s73, s80, s73
    v_mfma_f32_16x16x32_bf16 v[104:107], a[188:191], v[20:23], v[104:107]
    ds_read_b64_tr_b16 a[162:163], v36 offset:5888
    v_add_u32_e64 v4, s73, v4
    v_lshl_add_u32 v45, v4, 10, v2
    v_mfma_f32_16x16x32_bf16 v[144:147], a[180:183], a[196:199], v[144:147]
    s_add_u32 m0, s66, 45056
    ds_read_b128 a[208:211], v33 offset:6144
    buffer_load_dwordx4 v12, s[8:11], s51 offen lds
    v_lshrrev_b32 v1, 2, v0
    v_mfma_f32_16x16x32_bf16 v[128:131], a[164:167], a[196:199], v[128:131]
    ds_read_b64 v[156:157], v40 offset:4096
    s_lshl_b32 s73, s81, 4
    v_add_u32_e64 v1, s73, v1
    v_mfma_f32_16x16x32_bf16 v[132:135], a[168:171], a[196:199], v[132:135]
    ds_read_b64 v[158:159], v41 offset:4096
    v_mul_u32_u24 v1, 2752, v1
    v_and_b32 v3, 3, v3
    v_mfma_f32_16x16x32_bf16 v[136:139], a[172:175], a[196:199], v[136:139]
    s_waitcnt lgkmcnt(12)
    ds_read_b64 v[160:161], v42 offset:4096
    v_mfma_f32_16x16x32_bf16 v[140:143], a[176:179], a[196:199], v[140:143]
    ds_read_b64 v[162:163], v43 offset:4096
    s_waitcnt vmcnt(15) lgkmcnt(0)
    s_barrier
    v_mfma_f32_16x16x32_bf16 v[148:151], a[148:151], a[148:151], v[148:151]
    s_add_u32 m0, s66, 49152
    ds_read_b128 a[184:187], v29 offset:6144
    buffer_load_dwordx4 v15, s[8:11], s51 offen lds
    v_mfma_f32_16x16x32_bf16 v[152:155], a[208:211], a[208:211], v[152:155]
    s_add_u32 m0, s66, 53248
    ds_read_b64_tr_b16 a[192:193], v36 offset:16512
    buffer_load_dwordx4 v16, s[8:11], s51 offen lds
    v_mfma_f32_16x16x32_bf16 v[124:127], a[156:159], a[144:147], v[124:127]
    ds_read_b128 a[180:183], v19 offset:22528
    s_mul_i32 s73, s90, 192
    v_mfma_f32_16x16x32_bf16 v[108:111], a[156:159], a[128:131], v[108:111]
    ds_read_b64_tr_b16 a[194:195], v36 offset:18048
    s_mov_b32 exec_hi, 0x3
    s_mov_b32 exec_lo, 0xffff
    buffer_load_dword v6, v38, s[32:35], 0 offen
    s_mov_b64 exec, -1
    v_mfma_f32_16x16x32_bf16 v[112:115], a[156:159], a[132:135], v[112:115]
    ds_read_b128 a[164:167], v19 offset:6144
    v_lshl_add_u32 v3, v3, 4, s73
    v_add_u32_e64 v1, v1, v3
    v_mfma_f32_16x16x32_bf16 v[116:119], a[156:159], a[136:139], v[116:119]
    s_add_u32 m0, s66, 57344
    ds_read_b64_tr_b16 a[188:189], v36 offset:16384
    buffer_load_dwordx4 v10, s[8:11], s52 offen lds
    s_cmp_ge_u32 s90, 15
    s_cselect_b32 s73, 2146435072, 0
    v_mfma_f32_16x16x32_bf16 v[120:123], a[156:159], a[140:143], v[120:123]
L_warm_0:
    s_cbranch_execz L_warm_4
    ds_read_b128 a[168:171], v19 offset:10240
    v_add_u32_e64 v46, s73, v1
    v_mfma_f32_16x16x32_bf16 v[100:103], a[152:155], a[140:143], v[100:103]
    s_add_u32 m0, s66, 61440
    ds_read_b64_tr_b16 a[190:191], v36 offset:17920
    buffer_load_dwordx4 v13, s[8:11], s52 offen lds
    v_add_u32 v47, 88064, v46
    v_mfma_f32_16x16x32_bf16 v[96:99], a[152:155], a[136:139], v[96:99]
    s_add_u32 m0, s66, 65536
    ds_read_b128 a[172:175], v19 offset:14336
    buffer_load_dwordx4 v14, s[8:11], s52 offen lds
    s_cmp_ge_u32 s90, 14
    s_cselect_b32 s73, 2146435072, 0
    v_mfma_f32_16x16x32_bf16 v[92:95], a[152:155], a[132:135], v[92:95]
    ds_read_b64_tr_b16 a[196:197], v36 offset:16640
    v_add_u32 v48, s73, v1
    v_mfma_f32_16x16x32_bf16 v[88:91], a[152:155], a[128:131], v[88:91]
    s_add_u32 m0, s66, 69632
    ds_read_b128 a[176:179], v19 offset:18432
    buffer_load_dwordx4 v12, s[8:11], s52 offen lds
    v_add_u32 v49, 88064, v48
    v_mfma_f32_16x16x32_bf16 v[104:107], a[152:155], v[20:23], v[104:107]
    ds_read_b64_tr_b16 a[198:199], v36 offset:18176
    s_cmp_eq_u32 s71, 0
    s_cselect_b32 s73, 0xf149f2ca, 0
    v_mfma_f32_16x16x32_bf16 v[144:147], a[144:147], a[160:163], v[144:147]
    s_add_u32 m0, s66, 73728
    s_nop 0
    buffer_load_dwordx4 v15, s[8:11], s52 offen lds
    v_mov_b32 v4, 0xf149f2ca
    v_mov_b32 v3, s73
    v_mfma_f32_16x16x32_bf16 v[128:131], a[128:131], a[160:163], v[128:131]
    v_lshlrev_b32 v1, 2, v5
    v_sub_u32 v1, v31, v1
    v_mov_b32 v50, 0
    v_mfma_f32_16x16x32_bf16 v[132:135], a[132:135], a[160:163], v[132:135]
    v_mov_b32 v51, 0
    v_subrev_u32 v2, 0, v1
    v_cmp_lt_u32 vcc, 7, v2
    v_mfma_f32_16x16x32_bf16 v[136:139], a[136:139], a[160:163], v[136:139]
    v_mfma_f32_16x16x32_bf16 v[140:143], a[140:143], a[160:163], v[140:143]
    s_waitcnt vmcnt(15) lgkmcnt(0)
    s_barrier
    v_mfma_f32_16x16x32_bf16 v[148:151], a[184:187], a[184:187], v[148:151]
    s_add_u32 m0, s66, 77824
    ds_read_b128 a[148:151], v28 offset:24576
    buffer_load_dwordx4 v16, s[8:11], s52 offen lds
    v_mfma_f32_16x16x32_bf16 v[124:127], a[192:195], a[180:183], v[124:127]
    ds_read_b64_tr_b16 a[156:157], v36 offset:28800
    v_or_b32 v68, 0xffff, v50
    v_mfma_f32_16x16x32_bf16 v[108:111], a[192:195], a[164:167], v[108:111]
    s_add_u32 m0, s66, 4096
    ds_read_b128 a[144:147], v18 offset:40960
    buffer_load_dwordx4 v7, s[4:7], s75 offen lds
    v_mfma_f32_16x16x32_bf16 v[112:115], a[192:195], a[168:171], v[112:115]
    ds_read_b64_tr_b16 a[158:159], v36 offset:30336
    v_cndmask_b32 v52, 0, v4, vcc
    v_mfma_f32_16x16x32_bf16 v[116:119], a[192:195], a[172:175], v[116:119]
    s_add_u32 m0, s66, 8192
    ds_read_b128 a[128:131], v18 offset:24576
    buffer_load_dwordx4 v8, s[4:7], s75 offen lds
    v_mfma_f32_16x16x32_bf16 v[120:123], a[192:195], a[176:179], v[120:123]
    ds_read_b64_tr_b16 a[152:153], v36 offset:28672
    v_cndmask_b32 v50, v68, v50, vcc
    v_cmp_lt_i32 vcc, -9, v2
    v_mfma_f32_16x16x32_bf16 v[100:103], a[188:191], a[176:179], v[100:103]
    s_add_u32 m0, s66, 11264
    ds_read_b128 a[132:135], v18 offset:28672
    buffer_load_dwordx4 v7, s[4:7], s75 offen offset:1024 lds
    v_cndmask_b32 v56, 0, v4, vcc
    v_mfma_f32_16x16x32_bf16 v[96:99], a[188:191], a[172:175], v[96:99]
    ds_read_b64_tr_b16 a[154:155], v36 offset:30208
    v_cndmask_b32 v64, v3, v4, vcc
    v_cmp_gt_i32 vcc, 0, v2
    v_mfma_f32_16x16x32_bf16 v[92:95], a[188:191], a[168:171], v[92:95]
    s_add_u32 m0, s66, 15360
    ds_read_b128 a[136:139], v18 offset:32768
    buffer_load_dwordx4 v8, s[4:7], s75 offen offset:1024 lds
    s_mov_b32 vcc_hi, 0
    v_mfma_f32_16x16x32_bf16 v[88:91], a[188:191], a[164:167], v[88:91]
    ds_read_b64_tr_b16 a[160:161], v36 offset:28928
    v_cndmask_b32 v60, v4, v3, vcc
    v_subrev_u32 v2, 1, v1
    v_mfma_f32_16x16x32_bf16 v[104:107], a[188:191], v[20:23], v[104:107]
    s_add_u32 m0, s66, 20480
    ds_read_b128 a[140:143], v18 offset:36864
    s_mov_b64 exec, s[58:59]
    buffer_load_dwordx4 v9, s[4:7], s75 offen lds
    s_mov_b64 exec, -1
    v_cmp_lt_u32 vcc, 7, v2
    v_mfma_f32_16x16x32_bf16 v[144:147], a[180:183], a[196:199], v[144:147]
    s_add_u32 s75, s75, 256
    s_and_b32 s75, s75, 0x3ff
    ds_read_b64_tr_b16 a[162:163], v36 offset:30464
    v_or_b32 v68, 0xffff0000, v50
    v_cndmask_b32 v53, 0, v4, vcc
    v_mfma_f32_16x16x32_bf16 v[128:131], a[164:167], a[196:199], v[128:131]
    ds_read_b128 a[208:211], v33 offset:24576
    v_cndmask_b32 v50, v68, v50, vcc
    v_cmp_lt_i32 vcc, -9, v2
    v_mfma_f32_16x16x32_bf16 v[132:135], a[168:171], a[196:199], v[132:135]
    s_nop 0
    v_cndmask_b32 v57, 0, v4, vcc
    v_cndmask_b32 v65, v3, v4, vcc
    v_cmp_gt_i32 vcc, 0, v2
    v_mfma_f32_16x16x32_bf16 v[136:139], a[172:175], a[196:199], v[136:139]
    v_mfma_f32_16x16x32_bf16 v[140:143], a[176:179], a[196:199], v[140:143]
    s_waitcnt vmcnt(18) lgkmcnt(0)
    s_barrier
    v_mfma_f32_16x16x32_bf16 v[148:151], a[148:151], a[148:151], v[148:151]
    s_add_u32 m0, s66, 81920
    ds_read_b128 a[184:187], v29 offset:24576
    buffer_load_dwordx4 v10, s[8:11], s53 offen lds
    v_mfma_f32_16x16x32_bf16 v[152:155], a[208:211], a[208:211], v[152:155]
    ds_read_b64_tr_b16 a[192:193], v36 offset:41088
    s_mov_b32 vcc_hi, 0
    v_mfma_f32_16x16x32_bf16 v[124:127], a[156:159], a[144:147], v[124:127]
    s_add_u32 m0, s66, 86016
    ds_read_b128 a[180:183], v19 offset:40960
    buffer_load_dwordx4 v13, s[8:11], s53 offen lds
    v_mfma_f32_16x16x32_bf16 v[108:111], a[156:159], a[128:131], v[108:111]
    ds_read_b64_tr_b16 a[194:195], v36 offset:42624
    v_cndmask_b32 v61, v4, v3, vcc
    v_mfma_f32_16x16x32_bf16 v[112:115], a[156:159], a[132:135], v[112:115]
    s_add_u32 m0, s66, 90112
    ds_read_b128 a[164:167], v19 offset:24576
    buffer_load_dwordx4 v14, s[8:11], s53 offen lds
    v_mfma_f32_16x16x32_bf16 v[116:119], a[156:159], a[136:139], v[116:119]
    ds_read_b64_tr_b16 a[188:189], v36 offset:40960
    v_subrev_u32 v2, 2, v1
    v_mfma_f32_16x16x32_bf16 v[120:123], a[156:159], a[140:143], v[120:123]
    ds_read_b128 a[168:171], v19 offset:28672
    v_cmp_lt_u32 vcc, 7, v2
    v_mfma_f32_16x16x32_bf16 v[100:103], a[152:155], a[140:143], v[100:103]
    s_add_u32 m0, s66, 94208
    ds_read_b64_tr_b16 a[190:191], v36 offset:42496
    buffer_load_dwordx4 v12, s[8:11], s53 offen lds
    v_mfma_f32_16x16x32_bf16 v[96:99], a[152:155], a[136:139], v[96:99]
    ds_read_b128 a[172:175], v19 offset:32768
    v_or_b32 v68, 0xffff, v51
    v_mfma_f32_16x16x32_bf16 v[92:95], a[152:155], a[132:135], v[92:95]
    s_add_u32 m0, s66, 98304
    ds_read_b64_tr_b16 a[196:197], v36 offset:41216
    buffer_load_dwordx4 v15, s[8:11], s53 offen lds
    v_cndmask_b32 v54, 0, v4, vcc
    v_mfma_f32_16x16x32_bf16 v[88:91], a[152:155], a[128:131], v[88:91]
    ds_read_b128 a[176:179], v19 offset:36864
    v_cndmask_b32 v51, v68, v51, vcc
    v_cmp_lt_i32 vcc, -9, v2
    v_mfma_f32_16x16x32_bf16 v[104:107], a[152:155], v[20:23], v[104:107]
    s_add_u32 m0, s66, 102400
    ds_read_b64_tr_b16 a[198:199], v36 offset:42752
    buffer_load_dwordx4 v16, s[8:11], s53 offen lds
    v_cndmask_b32 v58, 0, v4, vcc
    v_mfma_f32_16x16x32_bf16 v[144:147], a[144:147], a[160:163], v[144:147]
    v_cndmask_b32 v66, v3, v4, vcc
    v_cmp_gt_i32 vcc, 0, v2
    s_mov_b32 vcc_hi, 0
    v_mfma_f32_16x16x32_bf16 v[128:131], a[128:131], a[160:163], v[128:131]
    v_cndmask_b32 v62, v4, v3, vcc
    v_subrev_u32 v2, 3, v1
    v_cmp_lt_u32 vcc, 7, v2
    v_mfma_f32_16x16x32_bf16 v[132:135], a[132:135], a[160:163], v[132:135]
    v_or_b32 v68, 0xffff0000, v51
    v_cndmask_b32 v55, 0, v4, vcc
    v_cndmask_b32 v51, v68, v51, vcc
    v_mfma_f32_16x16x32_bf16 v[136:139], a[136:139], a[160:163], v[136:139]
    v_mfma_f32_16x16x32_bf16 v[140:143], a[140:143], a[160:163], v[140:143]
    s_waitcnt vmcnt(21) lgkmcnt(0)
    s_barrier
    v_mfma_f32_16x16x32_bf16 v[148:151], a[184:187], a[184:187], v[148:151]
    s_add_u32 m0, s66, 106496
    ds_read_b128 a[148:151], v28 offset:26624
    buffer_load_dwordx4 v10, s[8:11], s54 offen lds
    v_mfma_f32_16x16x32_bf16 v[124:127], a[192:195], a[180:183], v[124:127]
    ds_read_b64_tr_b16 a[156:157], v36 offset:53376
    v_cmp_lt_i32 vcc, -9, v2
    v_mfma_f32_16x16x32_bf16 v[108:111], a[192:195], a[164:167], v[108:111]
    ds_read_b128 a[144:147], v18 offset:43008
    v_cndmask_b32 v59, 0, v4, vcc
    v_mfma_f32_16x16x32_bf16 v[112:115], a[192:195], a[168:171], v[112:115]
    s_add_u32 m0, s66, 110592
    ds_read_b64_tr_b16 a[158:159], v36 offset:54912
    buffer_load_dwordx4 v13, s[8:11], s54 offen lds
    v_mfma_f32_16x16x32_bf16 v[116:119], a[192:195], a[172:175], v[116:119]
    ds_read_b128 a[128:131], v18 offset:26624
    v_cndmask_b32 v67, v3, v4, vcc
    v_mfma_f32_16x16x32_bf16 v[120:123], a[192:195], a[176:179], v[120:123]
    ds_read_b64_tr_b16 a[152:153], v36 offset:53248
    v_cmp_gt_i32 vcc, 0, v2
    v_mfma_f32_16x16x32_bf16 v[100:103], a[188:191], a[176:179], v[100:103]
    s_add_u32 m0, s66, 114688
    ds_read_b128 a[132:135], v18 offset:30720
    buffer_load_dwordx4 v14, s[8:11], s54 offen lds
    v_mfma_f32_16x16x32_bf16 v[96:99], a[188:191], a[172:175], v[96:99]
    ds_read_b64_tr_b16 a[154:155], v36 offset:54784
    s_mov_b32 vcc_hi, 0
    v_cndmask_b32 v63, v4, v3, vcc
    v_mfma_f32_16x16x32_bf16 v[92:95], a[188:191], a[168:171], v[92:95]
    ds_read_b128 a[136:139], v18 offset:34816
    s_getreg_b32 s78, hwreg(HW_REG_XCC_ID, 0, 4)
    s_or_b32 s78, s78, 0x80
    v_mfma_f32_16x16x32_bf16 v[88:91], a[188:191], a[164:167], v[88:91]
    s_mov_b32 s82, 0
    ds_read_b64_tr_b16 a[160:161], v36 offset:53504
    buffer_load_dwordx4 a[216:219], v39, s[12:15], s82 offen offset:0
    v_mov_b32_e64 v74, s78
    v_mfma_f32_16x16x32_bf16 v[104:107], a[188:191], v[20:23], v[104:107]
    ds_read_b128 a[140:143], v18 offset:38912
    s_mov_b64 s[60:61], 0
    v_mov_b32 v1, s3
    v_mfma_f32_16x16x32_bf16 v[144:147], a[180:183], a[196:199], v[144:147]
    ds_read_b64_tr_b16 a[162:163], v36 offset:55040
    v_mov_b32 v2, s85
    v_mov_b32 v3, s90
    v_mfma_f32_16x16x32_bf16 v[128:131], a[164:167], a[196:199], v[128:131]
    ds_read_b128 a[208:211], v33 offset:26624
    v_mov_b32 v4, s84
    v_cmp_gt_u32 vcc, 2, v0
    v_mfma_f32_16x16x32_bf16 v[132:135], a[168:171], a[196:199], v[132:135]
    s_nop 0
    v_cndmask_b32 v1, v1, v2, vcc
    v_cndmask_b32 v3, v3, v4, vcc
    v_lshl_add_u32 v1, v0, 2, v1
    v_mfma_f32_16x16x32_bf16 v[136:139], a[172:175], a[196:199], v[136:139]
    v_mfma_f32_16x16x32_bf16 v[140:143], a[176:179], a[196:199], v[140:143]
    s_waitcnt vmcnt(22) lgkmcnt(0)
    s_barrier
    v_mfma_f32_16x16x32_bf16 v[148:151], a[148:151], a[148:151], v[148:151]
    s_add_u32 m0, s66, 118784
    ds_read_b128 a[184:187], v29 offset:26624
    buffer_load_dwordx4 v12, s[8:11], s54 offen lds
    v_mfma_f32_16x16x32_bf16 v[152:155], a[208:211], a[208:211], v[152:155]
    ds_read_b64_tr_b16 a[192:193], v35 offset:45184
    s_add_u32 s73, s72, 667648
    v_mfma_f32_16x16x32_bf16 v[124:127], a[156:159], a[144:147], v[124:127]
    ds_read_b128 a[180:183], v19 offset:43008
    v_lshl_add_u32 v3, v3, 2, s73
    v_mfma_f32_16x16x32_bf16 v[108:111], a[156:159], a[128:131], v[108:111]
    s_add_u32 m0, s66, 122880
    ds_read_b64_tr_b16 a[194:195], v35 offset:46720
    buffer_load_dwordx4 v15, s[8:11], s54 offen lds
    v_mfma_f32_16x16x32_bf16 v[112:115], a[156:159], a[132:135], v[112:115]
    ds_read_b128 a[164:167], v19 offset:26624
    v_lshl_add_u32 v69, v1, 7, v3
    v_mfma_f32_16x16x32_bf16 v[116:119], a[156:159], a[136:139], v[116:119]
    ds_read_b64_tr_b16 a[188:189], v35 offset:45056
    v_lshl_add_u32 v70, v1, 6, v3
    v_mfma_f32_16x16x32_bf16 v[120:123], a[156:159], a[140:143], v[120:123]
    ds_read_b128 a[168:171], v19 offset:30720
    v_lshl_add_u32 v3, v31, 2, s73
    v_mfma_f32_16x16x32_bf16 v[100:103], a[152:155], a[140:143], v[100:103]
    s_add_u32 m0, s66, 126976
    ds_read_b64_tr_b16 a[190:191], v35 offset:46592
    buffer_load_dwordx4 v16, s[8:11], s54 offen lds
    v_mfma_f32_16x16x32_bf16 v[96:99], a[152:155], a[136:139], v[96:99]
    ds_read_b128 a[172:175], v19 offset:34816
    v_lshl_add_u32 v71, v5, 7, v3
    v_mfma_f32_16x16x32_bf16 v[92:95], a[152:155], a[132:135], v[92:95]
    ds_read_b64_tr_b16 a[196:197], v35 offset:45312
    s_lshl_b32 s74, s3, 7
    v_mfma_f32_16x16x32_bf16 v[88:91], a[152:155], a[128:131], v[88:91]
    s_mov_b32 s82, 0
    ds_read_b128 a[176:179], v19 offset:38912
    buffer_load_dwordx4 a[220:223], v39, s[12:15], s82 offen offset:1024
    v_mfma_f32_16x16x32_bf16 v[104:107], a[152:155], v[20:23], v[104:107]
    ds_read_b64_tr_b16 a[198:199], v35 offset:46848
    v_add_u32 v72, s74, v3
    v_min_u32 v3, 14, v31
    v_mfma_f32_16x16x32_bf16 v[144:147], a[144:147], a[160:163], v[144:147]
    v_lshl_add_u32 v3, v3, 2, s73
    v_mov_b32 v1, s3
    v_cmp_gt_u32 vcc, 16, v0
    v_mfma_f32_16x16x32_bf16 v[128:131], a[128:131], a[160:163], v[128:131]
    s_nop 0
    v_cndmask_b32 v1, v1, v2, vcc
    v_lshl_add_u32 v73, v1, 7, v3
    s_lshl_b32 s73, s3, 5
    v_mfma_f32_16x16x32_bf16 v[132:135], a[132:135], a[160:163], v[132:135]
    v_xor_b32 v75, s73, v30
    v_and_b32 v2, 1, v5
    v_and_b32_e64 v3, 3, v0
    v_mfma_f32_16x16x32_bf16 v[136:139], a[136:139], a[160:163], v[136:139]
    v_mfma_f32_16x16x32_bf16 v[140:143], a[140:143], a[160:163], v[140:143]
    s_waitcnt vmcnt(14) lgkmcnt(0)
    s_barrier
    v_mfma_f32_16x16x32_bf16 v[148:151], a[184:187], a[184:187], v[148:151]
    s_add_u32 m0, s66, 24576
    ds_read_b128 a[148:151], v28 offset:4096
    buffer_load_dwordx4 v7, s[4:7], s75 offen lds
    v_mfma_f32_16x16x32_bf16 v[124:127], a[192:195], a[180:183], v[124:127]
    ds_read_b64_tr_b16 a[156:157], v35 offset:57472
    v_lshl_add_u32 v3, v2, 2, v3
    v_mfma_f32_16x16x32_bf16 v[108:111], a[192:195], a[164:167], v[108:111]
    s_add_u32 m0, s66, 28672
    ds_read_b128 a[144:147], v18 offset:20480
    buffer_load_dwordx4 v8, s[4:7], s75 offen lds
    v_mfma_f32_16x16x32_bf16 v[112:115], a[192:195], a[168:171], v[112:115]
    ds_read_b64_tr_b16 a[158:159], v35 offset:59008
    v_lshlrev_b32_e64 v3, 3, v3
    v_mfma_f32_16x16x32_bf16 v[116:119], a[192:195], a[172:175], v[116:119]
    s_add_u32 m0, s66, 31744
    ds_read_b128 a[128:131], v18 offset:4096
    buffer_load_dwordx4 v7, s[4:7], s75 offen offset:1024 lds
    v_mfma_f32_16x16x32_bf16 v[120:123], a[192:195], a[176:179], v[120:123]
    ds_read_b64_tr_b16 a[152:153], v35 offset:57344
    v_lshrrev_b32 v1, 2, v0
    v_lshl_add_u32 v76, v1, 6, v3
    v_mfma_f32_16x16x32_bf16 v[100:103], a[188:191], a[176:179], v[100:103]
    s_add_u32 m0, s66, 35840
    ds_read_b128 a[132:135], v18 offset:8192
    buffer_load_dwordx4 v8, s[4:7], s75 offen offset:1024 lds
    v_lshlrev_b32 v1, 4, v31
    v_mfma_f32_16x16x32_bf16 v[96:99], a[188:191], a[172:175], v[96:99]
    ds_read_b64_tr_b16 a[154:155], v35 offset:58880
    v_lshl_add_u32 v1, v32, 8, v1
    v_lshl_add_u32 v82, v2, 14, v1
    v_mfma_f32_16x16x32_bf16 v[92:95], a[188:191], a[168:171], v[92:95]
    s_add_u32 m0, s66, 40960
    ds_read_b128 a[136:139], v18 offset:12288
    s_mov_b64 exec, s[58:59]
    buffer_load_dwordx4 v9, s[4:7], s75 offen lds
    s_mov_b64 exec, -1
    s_mov_b32 s73, 0
    v_mfma_f32_16x16x32_bf16 v[88:91], a[188:191], a[164:167], v[88:91]
    ds_read_b64_tr_b16 a[160:161], v35 offset:57600
    v_lshl_add_u32 v78, v31, 2, s73
    v_lshl_add_u32 v80, v5, 4, s73
    v_mfma_f32_16x16x32_bf16 v[104:107], a[188:191], v[20:23], v[104:107]
    s_add_u32 m0, s66, 45056
    ds_read_b128 a[140:143], v18 offset:16384
    buffer_load_dwordx4 v10, s[8:11], s55 offen lds
    v_and_b32 v3, 1, v0
    v_mfma_f32_16x16x32_bf16 v[144:147], a[180:183], a[196:199], v[144:147]
    ds_read_b64_tr_b16 a[162:163], v35 offset:59136
    v_lshl_add_u32 v77, v3, 10, v80
    s_lshl_b32 s74, s3, 6
    v_mfma_f32_16x16x32_bf16 v[128:131], a[164:167], a[196:199], v[128:131]
    ds_read_b128 a[208:211], v33 offset:4096
    v_add_u32 v79, s74, v78
    v_and_b32_e64 v1, 12, v0
    v_mfma_f32_16x16x32_bf16 v[132:135], a[168:171], a[196:199], v[132:135]
    v_lshl_add_u32 v1, v1, 2, v31
    v_lshlrev_b32 v83, 2, v1
    s_lshl_b32 s73, s3, 6
    v_mfma_f32_16x16x32_bf16 v[136:139], a[172:175], a[196:199], v[136:139]
    v_mfma_f32_16x16x32_bf16 v[140:143], a[176:179], a[196:199], v[140:143]
    s_waitcnt lgkmcnt(0)
    s_barrier
    v_mfma_f32_16x16x32_bf16 v[148:151], a[148:151], a[148:151], v[148:151]
    s_add_u32 m0, s66, 49152
    ds_read_b128 a[184:187], v29 offset:4096
    buffer_load_dwordx4 v13, s[8:11], s55 offen lds
    v_mfma_f32_16x16x32_bf16 v[152:155], a[208:211], a[208:211], v[152:155]
    ds_read_b64_tr_b16 a[192:193], v36 offset:4224
    s_add_u32 s73, s73, s72
    v_mfma_f32_16x16x32_bf16 v[124:127], a[156:159], a[144:147], v[124:127]
    s_add_u32 m0, s66, 53248
    ds_read_b128 a[180:183], v19 offset:20480
    buffer_load_dwordx4 v14, s[8:11], s55 offen lds
    v_mfma_f32_16x16x32_bf16 v[108:111], a[156:159], a[128:131], v[108:111]
    ds_read_b64_tr_b16 a[194:195], v36 offset:5760
    s_add_u32 s73, s73, 663552
    v_mfma_f32_16x16x32_bf16 v[112:115], a[156:159], a[132:135], v[112:115]
    s_mov_b32 s82, 0
    ds_read_b128 a[164:167], v19 offset:4096
    buffer_load_dwordx4 a[224:227], v39, s[12:15], s82 offen offset:2048
    v_mfma_f32_16x16x32_bf16 v[116:119], a[156:159], a[136:139], v[116:119]
    ds_read_b64_tr_b16 a[188:189], v36 offset:4096
    s_cmp_lt_u32 s3, 2
    s_cselect_b32 s73, s73, 2146435072
    v_mfma_f32_16x16x32_bf16 v[120:123], a[156:159], a[140:143], v[120:123]
    ds_read_b128 a[168:171], v19 offset:8192
    v_lshrrev_b32 v1, 2, v0
    v_mfma_f32_16x16x32_bf16 v[100:103], a[152:155], a[140:143], v[100:103]
    ds_read_b64_tr_b16 a[190:191], v36 offset:5632
    s_mov_b64 exec, 0x1fff
    buffer_load_dword v6, v24, s[20:23], 0 offen
    s_mov_b64 exec, -1
    v_mfma_f32_16x16x32_bf16 v[96:99], a[152:155], a[136:139], v[96:99]
    ds_read_b128 a[172:175], v19 offset:12288
    v_and_b32 v2, 0x30, v17
    v_mfma_f32_16x16x32_bf16 v[92:95], a[152:155], a[132:135], v[92:95]
    s_add_u32 m0, s66, 57344
    ds_read_b64_tr_b16 a[196:197], v36 offset:4352
    buffer_load_dwordx4 v12, s[8:11], s55 offen lds
    v_lshl_add_u32 v1, v1, 7, v2
    v_mfma_f32_16x16x32_bf16 v[88:91], a[152:155], a[128:131], v[88:91]
    ds_read_b128 a[176:179], v19 offset:16384
    v_add_u32_e64 v81, s73, v1
    v_bfe_u32 v1, v0, 2, 1
    v_mfma_f32_16x16x32_bf16 v[104:107], a[152:155], v[20:23], v[104:107]
    s_add_u32 m0, s66, 61440
    ds_read_b64_tr_b16 a[198:199], v36 offset:5888
    buffer_load_dwordx4 v15, s[8:11], s55 offen lds
    v_bfe_u32 v2, v0, 3, 1
    v_mfma_f32_16x16x32_bf16 v[144:147], a[144:147], a[160:163], v[144:147]
    v_lshl_add_u32 v1, v1, 2, v5
    v_lshl_add_u32 v1, v2, 5, v1
    v_lshlrev_b32_e64 v84, 1, v1
    v_mfma_f32_16x16x32_bf16 v[128:131], a[128:131], a[160:163], v[128:131]
    s_mov_b32 s36, 0x22222222
    s_mov_b32 s37, 0x22222222
    s_mov_b32 s38, 0x88888888
    v_mfma_f32_16x16x32_bf16 v[132:135], a[132:135], a[160:163], v[132:135]
    s_mov_b32 s39, 0x88888888
    s_mov_b32 s40, 0xcccccccc
    s_mov_b32 s41, 0xcccccccc
    v_mfma_f32_16x16x32_bf16 v[136:139], a[136:139], a[160:163], v[136:139]
    v_mfma_f32_16x16x32_bf16 v[140:143], a[140:143], a[160:163], v[140:143]
    s_waitcnt vmcnt(23) lgkmcnt(0)
    s_barrier
    v_mfma_f32_16x16x32_bf16 v[148:151], a[184:187], a[184:187], v[148:151]
    s_add_u32 m0, s66, 65536
    ds_read_b128 a[148:151], v28 offset:6144
    buffer_load_dwordx4 v16, s[8:11], s55 offen lds
    v_mfma_f32_16x16x32_bf16 v[124:127], a[192:195], a[180:183], v[124:127]
    ds_read_b64_tr_b16 a[156:157], v36 offset:16512
    v_mfma_f32_16x16x32_bf16 v[108:111], a[192:195], a[164:167], v[108:111]
    s_mov_b32 s82, 0
    ds_read_b128 a[144:147], v18 offset:22528
    buffer_load_dwordx4 a[228:231], v39, s[12:15], s82 offen offset:3072
    v_mfma_f32_16x16x32_bf16 v[112:115], a[192:195], a[168:171], v[112:115]
    ds_read_b64_tr_b16 a[158:159], v36 offset:18048
    v_mfma_f32_16x16x32_bf16 v[116:119], a[192:195], a[172:175], v[116:119]
    ds_read_b128 a[128:131], v18 offset:6144
    v_mfma_f32_16x16x32_bf16 v[120:123], a[192:195], a[176:179], v[120:123]
    s_lshl_b32 s82, s70, 4
    ds_read_b64_tr_b16 a[152:153], v36 offset:16384
    buffer_load_dword v85, off, s[28:31], s82 sc1
    v_mfma_f32_16x16x32_bf16 v[100:103], a[188:191], a[176:179], v[100:103]
    ds_read_b128 a[132:135], v18 offset:10240
    v_mfma_f32_16x16x32_bf16 v[96:99], a[188:191], a[172:175], v[96:99]
    s_mov_b32 s82, 4096
    ds_read_b64_tr_b16 a[154:155], v36 offset:17920
    buffer_load_dwordx4 a[232:235], v39, s[12:15], s82 offen offset:0
    v_mfma_f32_16x16x32_bf16 v[92:95], a[188:191], a[168:171], v[92:95]
    ds_read_b128 a[136:139], v18 offset:14336
    v_mfma_f32_16x16x32_bf16 v[88:91], a[188:191], a[164:167], v[88:91]
    ds_read_b64_tr_b16 a[160:161], v36 offset:16640
    v_mfma_f32_16x16x32_bf16 v[104:107], a[188:191], v[20:23], v[104:107]
    s_mov_b32 s82, 4096
    ds_read_b128 a[140:143], v18 offset:18432
    buffer_load_dwordx4 a[236:239], v39, s[12:15], s82 offen offset:1024
    v_mfma_f32_16x16x32_bf16 v[144:147], a[180:183], a[196:199], v[144:147]
    ds_read_b64_tr_b16 a[162:163], v36 offset:18176
    v_mfma_f32_16x16x32_bf16 v[128:131], a[164:167], a[196:199], v[128:131]
    ds_read_b128 a[208:211], v33 offset:6144
    v_mfma_f32_16x16x32_bf16 v[132:135], a[168:171], a[196:199], v[132:135]
    v_mfma_f32_16x16x32_bf16 v[136:139], a[172:175], a[196:199], v[136:139]
    v_mfma_f32_16x16x32_bf16 v[140:143], a[176:179], a[196:199], v[140:143]
    s_waitcnt vmcnt(25) lgkmcnt(0)
    s_barrier
    v_mfma_f32_16x16x32_bf16 v[148:151], a[148:151], a[148:151], v[148:151]
    s_mov_b32 s82, 4096
    ds_read_b128 a[184:187], v29 offset:6144
    buffer_load_dwordx4 a[240:243], v39, s[12:15], s82 offen offset:2048
    v_mfma_f32_16x16x32_bf16 v[152:155], a[208:211], a[208:211], v[152:155]
    s_add_u32 s76, s2, 0
    ds_read_b64_tr_b16 a[192:193], v36 offset:28800
    v_mfma_f32_16x16x32_bf16 v[124:127], a[156:159], a[144:147], v[124:127]
    s_and_b32 s76, s76, 7
    ds_read_b128 a[180:183], v19 offset:22528
    v_mfma_f32_16x16x32_bf16 v[108:111], a[156:159], a[128:131], v[108:111]
    s_mul_i32 s48, s76, 176128
    ds_read_b64_tr_b16 a[194:195], v36 offset:30336
    v_mfma_f32_16x16x32_bf16 v[112:115], a[156:159], a[132:135], v[112:115]
    s_add_u32 s76, s2, 1
    ds_read_b128 a[164:167], v19 offset:6144
    v_mfma_f32_16x16x32_bf16 v[116:119], a[156:159], a[136:139], v[116:119]
    s_and_b32 s76, s76, 7
    ds_read_b64_tr_b16 a[188:189], v36 offset:28672
    v_mfma_f32_16x16x32_bf16 v[120:123], a[156:159], a[140:143], v[120:123]
    s_mul_i32 s49, s76, 176128
    ds_read_b128 a[168:171], v19 offset:10240
    v_mfma_f32_16x16x32_bf16 v[100:103], a[152:155], a[140:143], v[100:103]
    s_mov_b32 s82, 4096
    ds_read_b64_tr_b16 a[190:191], v36 offset:30208
    buffer_load_dwordx4 a[244:247], v39, s[12:15], s82 offen offset:3072
    v_mfma_f32_16x16x32_bf16 v[96:99], a[152:155], a[136:139], v[96:99]
    s_add_u32 s76, s2, 2
    ds_read_b128 a[172:175], v19 offset:14336
    v_mfma_f32_16x16x32_bf16 v[92:95], a[152:155], a[132:135], v[92:95]
    s_and_b32 s76, s76, 7
    ds_read_b64_tr_b16 a[196:197], v36 offset:28928
    v_mfma_f32_16x16x32_bf16 v[88:91], a[152:155], a[128:131], v[88:91]
    s_mul_i32 s50, s76, 176128
    ds_read_b128 a[176:179], v19 offset:18432
    v_mfma_f32_16x16x32_bf16 v[104:107], a[152:155], v[20:23], v[104:107]
    s_add_u32 s76, s2, 3
    ds_read_b64_tr_b16 a[198:199], v36 offset:30464
    v_mfma_f32_16x16x32_bf16 v[144:147], a[144:147], a[160:163], v[144:147]
    s_and_b32 s76, s76, 7
    v_mfma_f32_16x16x32_bf16 v[128:131], a[128:131], a[160:163], v[128:131]
    s_mul_i32 s51, s76, 176128
    v_mfma_f32_16x16x32_bf16 v[132:135], a[132:135], a[160:163], v[132:135]
    v_mfma_f32_16x16x32_bf16 v[136:139], a[136:139], a[160:163], v[136:139]
    v_mfma_f32_16x16x32_bf16 v[140:143], a[140:143], a[160:163], v[140:143]
    s_waitcnt vmcnt(14) lgkmcnt(0)
    s_barrier
    v_mfma_f32_16x16x32_bf16 v[148:151], a[184:187], a[184:187], v[148:151]
    s_add_u32 m0, s66, 131072
    s_mov_b32 s77, 0
    ds_read_b128 a[148:151], v28 offset:24576
    buffer_load_dwordx4 v44, s[12:15], s77 offen lds
    v_mfma_f32_16x16x32_bf16 v[124:127], a[192:195], a[180:183], v[124:127]
    s_add_u32 s76, s2, 4
    ds_read_b64_tr_b16 a[156:157], v36 offset:41088
    v_mfma_f32_16x16x32_bf16 v[108:111], a[192:195], a[164:167], v[108:111]
    s_and_b32 s76, s76, 7
    ds_read_b128 a[144:147], v18 offset:40960
    v_mfma_f32_16x16x32_bf16 v[112:115], a[192:195], a[168:171], v[112:115]
    s_mov_b32 s77, 32768
    ds_read_b64_tr_b16 a[158:159], v36 offset:42624
    v_mfma_f32_16x16x32_bf16 v[116:119], a[192:195], a[172:175], v[116:119]
    s_add_u32 m0, s66, 135168
    ds_read_b128 a[128:131], v18 offset:24576
    buffer_load_dwordx4 v44, s[12:15], s77 offen lds
    v_mfma_f32_16x16x32_bf16 v[120:123], a[192:195], a[176:179], v[120:123]
    s_mul_i32 s52, s76, 176128
    ds_read_b64_tr_b16 a[152:153], v36 offset:40960
    v_mfma_f32_16x16x32_bf16 v[100:103], a[188:191], a[176:179], v[100:103]
    s_add_u32 s76, s2, 5
    ds_read_b128 a[132:135], v18 offset:28672
    v_mfma_f32_16x16x32_bf16 v[96:99], a[188:191], a[172:175], v[96:99]
    s_and_b32 s76, s76, 7
    ds_read_b128 a[136:139], v18 offset:32768
    v_mfma_f32_16x16x32_bf16 v[92:95], a[188:191], a[168:171], v[92:95]
    s_mul_i32 s53, s76, 176128
    ds_read_b64_tr_b16 a[154:155], v36 offset:42496
    s_mov_b64 exec, 0x1ffffff
    buffer_load_dword v6, v25, s[16:19], 0 offen
    s_mov_b64 exec, -1
    v_mfma_f32_16x16x32_bf16 v[88:91], a[188:191], a[164:167], v[88:91]
    s_add_u32 s76, s2, 6
    ds_read_b128 a[140:143], v18 offset:36864
    v_mfma_f32_16x16x32_bf16 v[104:107], a[188:191], v[20:23], v[104:107]
    s_and_b32 s76, s76, 7
    ds_read_b64_tr_b16 a[160:161], v36 offset:41216
    v_mfma_f32_16x16x32_bf16 v[144:147], a[180:183], a[196:199], v[144:147]
    s_mul_i32 s54, s76, 176128
    ds_read_b128 a[200:203], v28 offset:26624
    v_mfma_f32_16x16x32_bf16 v[128:131], a[164:167], a[196:199], v[128:131]
    s_add_u32 s76, s2, 7
    ds_read_b64_tr_b16 a[162:163], v36 offset:42752
    v_mfma_f32_16x16x32_bf16 v[132:135], a[168:171], a[196:199], v[132:135]
    s_and_b32 s76, s76, 7
    ds_read_b128 a[208:211], v33 offset:24576
    v_mfma_f32_16x16x32_bf16 v[136:139], a[172:175], a[196:199], v[136:139]
    s_mul_i32 s55, s76, 176128
    v_mfma_f32_16x16x32_bf16 v[140:143], a[176:179], a[196:199], v[140:143]
    s_waitcnt lgkmcnt(0)
    v_mfma_f32_16x16x32_bf16 v[148:151], a[148:151], a[148:151], v[148:151]
    s_add_u32 m0, s66, 139264
    s_mov_b32 s77, 65536
    ds_read_b128 a[184:187], v29 offset:24576
    buffer_load_dwordx4 v44, s[12:15], s77 offen lds
    v_mfma_f32_16x16x32_bf16 v[148:151], a[200:203], a[200:203], v[148:151]
    ds_read_b64_tr_b16 a[192:193], v36 offset:53376
    v_mfma_f32_16x16x32_bf16 v[152:155], a[208:211], a[208:211], v[152:155]
    ds_read_b128 a[180:183], v19 offset:40960
    v_mfma_f32_16x16x32_bf16 v[124:127], a[156:159], a[144:147], v[124:127]
    ds_read_b64_tr_b16 a[194:195], v36 offset:54912
    v_mfma_f32_16x16x32_bf16 v[108:111], a[156:159], a[128:131], v[108:111]
    s_mov_b32 s77, 98304
    ds_read_b128 a[164:167], v19 offset:24576
    v_mfma_f32_16x16x32_bf16 v[112:115], a[156:159], a[132:135], v[112:115]
    s_add_u32 m0, s66, 143360
    ds_read_b64_tr_b16 a[188:189], v36 offset:53248
    buffer_load_dwordx4 v44, s[12:15], s77 offen lds
    v_mfma_f32_16x16x32_bf16 v[116:119], a[156:159], a[136:139], v[116:119]
    ds_read_b128 a[168:171], v19 offset:28672
    v_mfma_f32_16x16x32_bf16 v[120:123], a[156:159], a[140:143], v[120:123]
    ds_read_b128 a[172:175], v19 offset:32768
    v_mfma_f32_16x16x32_bf16 v[100:103], a[152:155], a[140:143], v[100:103]
L_warm_1:
    s_cbranch_execz L_warm_5
    ds_read_b64_tr_b16 a[190:191], v36 offset:54784
    v_mfma_f32_16x16x32_bf16 v[96:99], a[152:155], a[136:139], v[96:99]
    ds_read_b128 a[176:179], v19 offset:36864
    v_mfma_f32_16x16x32_bf16 v[92:95], a[152:155], a[132:135], v[92:95]
    ds_read_b64_tr_b16 a[196:197], v36 offset:53504
    s_mov_b64 exec, s[44:45]
    buffer_load_dword v6, v26, s[32:35], 0 offen
    s_mov_b64 exec, -1
    v_mfma_f32_16x16x32_bf16 v[88:91], a[152:155], a[128:131], v[88:91]
    ds_read_b128 a[204:207], v29 offset:26624
    v_mfma_f32_16x16x32_bf16 v[104:107], a[152:155], v[20:23], v[104:107]
    ds_read_b64_tr_b16 a[198:199], v36 offset:55040
    v_mfma_f32_16x16x32_bf16 v[144:147], a[144:147], a[160:163], v[144:147]
    ds_read_b128 a[212:215], v33 offset:26624
    v_mfma_f32_16x16x32_bf16 v[128:131], a[128:131], a[160:163], v[128:131]
    v_mfma_f32_16x16x32_bf16 v[132:135], a[132:135], a[160:163], v[132:135]
    v_mfma_f32_16x16x32_bf16 v[136:139], a[136:139], a[160:163], v[136:139]
    v_mfma_f32_16x16x32_bf16 v[140:143], a[140:143], a[160:163], v[140:143]
    s_waitcnt vmcnt(12) lgkmcnt(0)
    s_barrier
    v_mfma_f32_16x16x32_bf16 v[148:151], a[184:187], a[184:187], v[148:151]
    s_add_u32 m0, s66, 147456
    s_mov_b32 s77, 131072
    ds_read_b128 a[144:147], v18 offset:43008
    buffer_load_dwordx4 v44, s[12:15], s77 offen lds
    v_mfma_f32_16x16x32_bf16 v[148:151], a[204:207], a[204:207], v[148:151]
    ds_read_b64_tr_b16 a[156:157], v35 offset:45184
    v_mfma_f32_16x16x32_bf16 v[152:155], a[212:215], a[212:215], v[152:155]
    ds_read_b64_tr_b16 a[158:159], v35 offset:46720
    v_mfma_f32_16x16x32_bf16 v[124:127], a[192:195], a[180:183], v[124:127]
    ds_read_b128 a[128:131], v18 offset:26624
    v_mfma_f32_16x16x32_bf16 v[108:111], a[192:195], a[164:167], v[108:111]
    ds_read_b64_tr_b16 a[152:153], v35 offset:45056
    v_mfma_f32_16x16x32_bf16 v[112:115], a[192:195], a[168:171], v[112:115]
    ds_read_b128 a[132:135], v18 offset:30720
    v_mfma_f32_16x16x32_bf16 v[116:119], a[192:195], a[172:175], v[116:119]
    s_mov_b32 s77, 163840
    ds_read_b64_tr_b16 a[154:155], v35 offset:46592
    v_mfma_f32_16x16x32_bf16 v[120:123], a[192:195], a[176:179], v[120:123]
    s_add_u32 m0, s66, 151552
    ds_read_b128 a[136:139], v18 offset:34816
    buffer_load_dwordx4 v44, s[12:15], s77 offen lds
    v_mfma_f32_16x16x32_bf16 v[100:103], a[188:191], a[176:179], v[100:103]
    ds_read_b64_tr_b16 a[160:161], v35 offset:45312
    v_mfma_f32_16x16x32_bf16 v[96:99], a[188:191], a[172:175], v[96:99]
    ds_read_b128 a[140:143], v18 offset:38912
    v_mfma_f32_16x16x32_bf16 v[92:95], a[188:191], a[168:171], v[92:95]
    ds_read_b64_tr_b16 a[162:163], v35 offset:46848
    v_mfma_f32_16x16x32_bf16 v[88:91], a[188:191], a[164:167], v[88:91]
    v_cndmask_b32 v149, v148, v149, s[36:37]
    v_mfma_f32_16x16x32_bf16 v[104:107], a[188:191], v[20:23], v[104:107]
    v_cndmask_b32 v150, v150, v151, s[38:39]
    v_cndmask_b32 v149, v149, v150, s[40:41]
    v_mfma_f32_16x16x32_bf16 v[144:147], a[180:183], a[196:199], v[144:147]
    v_cndmask_b32 v153, v152, v153, s[36:37]
    v_cndmask_b32 v154, v154, v155, s[38:39]
    v_mfma_f32_16x16x32_bf16 v[128:131], a[164:167], a[196:199], v[128:131]
    v_cndmask_b32 v153, v153, v154, s[40:41]
    v_mfma_f32_16x16x32_bf16 v[132:135], a[168:171], a[196:199], v[132:135]
    v_mfma_f32_16x16x32_bf16 v[136:139], a[172:175], a[196:199], v[136:139]
    v_mfma_f32_16x16x32_bf16 v[140:143], a[176:179], a[196:199], v[140:143]
    s_waitcnt lgkmcnt(0)
    v_mfma_f32_16x16x32_bf16 v[124:127], a[156:159], a[144:147], v[124:127]
    s_add_u32 m0, s66, 155648
    s_mov_b32 s77, 196608
    ds_bpermute_b32 v8, v83, v149
    buffer_load_dwordx4 v44, s[12:15], s77 offen lds
    v_mfma_f32_16x16x32_bf16 v[108:111], a[156:159], a[128:131], v[108:111]
    ds_bpermute_b32 v9, v83, v153
    v_mfma_f32_16x16x32_bf16 v[112:115], a[156:159], a[132:135], v[112:115]
    ds_read_b128 a[180:183], v19 offset:43008
    v_mfma_f32_16x16x32_bf16 v[116:119], a[156:159], a[136:139], v[116:119]
    ds_read_b64_tr_b16 a[192:193], v35 offset:57472
    v_add_f32_dpp v152, v152, v152 row_ror:8 row_mask:0xf bank_mask:0xf
    v_mfma_f32_16x16x32_bf16 v[120:123], a[156:159], a[140:143], v[120:123]
    ds_read_b64_tr_b16 a[194:195], v35 offset:59008
    v_mul_f32 v148, 0xbb000000, v148
    v_mfma_f32_16x16x32_bf16 v[100:103], a[152:155], a[140:143], v[100:103]
    ds_read_b128 a[164:167], v19 offset:26624
    v_mul_f32 v152, 0xbb000000, v152
    v_mfma_f32_16x16x32_bf16 v[96:99], a[152:155], a[136:139], v[96:99]
    ds_read_b64_tr_b16 a[188:189], v35 offset:57344
    s_waitcnt lgkmcnt(5)
    v_add_f32_dpp v9, v9, v9 row_ror:8 row_mask:0xf bank_mask:0xf
    v_mfma_f32_16x16x32_bf16 v[92:95], a[152:155], a[132:135], v[92:95]
    ds_read_b128 a[168:171], v19 offset:30720
    v_mul_f32 v8, 0x3b000000, v8
    v_mfma_f32_16x16x32_bf16 v[88:91], a[152:155], a[128:131], v[88:91]
    ds_read_b64_tr_b16 a[190:191], v35 offset:58880
    v_fma_f32 v8, -v148, v148, v8
    v_mfma_f32_16x16x32_bf16 v[104:107], a[152:155], v[20:23], v[104:107]
    s_mov_b32 s77, 229376
    ds_read_b128 a[172:175], v19 offset:34816
    v_max_f32_e64 v8, 0, v8
    v_mfma_f32_16x16x32_bf16 v[144:147], a[144:147], a[160:163], v[144:147]
    s_add_u32 m0, s66, 159744
    ds_read_b64_tr_b16 a[196:197], v35 offset:57600
    buffer_load_dwordx4 v44, s[12:15], s77 offen lds
    v_mfma_f32_16x16x32_bf16 v[128:131], a[128:131], a[160:163], v[128:131]
    ds_read_b128 a[176:179], v19 offset:38912
    v_add_f32 v8, 0x3727c5ac, v8
    v_mfma_f32_16x16x32_bf16 v[132:135], a[132:135], a[160:163], v[132:135]
    ds_read_b64_tr_b16 a[198:199], v35 offset:59136
    v_rsq_f32 v8, v8
    v_mfma_f32_16x16x32_bf16 v[136:139], a[136:139], a[160:163], v[136:139]
    v_mul_f32 v9, 0x3b000000, v9
    v_fma_f32 v9, -v152, v152, v9
    v_mfma_f32_16x16x32_bf16 v[140:143], a[140:143], a[160:163], v[140:143]
    v_max_f32 v9, 0, v9
    v_add_f32 v9, 0x3727c5ac, v9
    s_waitcnt vmcnt(10)
    v_mfma_f32_16x16x32_bf16 v[208:211], v[20:23], a[216:219], 0
    v_rsq_f32 v9, v9
    v_mfma_f32_16x16x32_bf16 v[212:215], v[20:23], a[220:223], 0
    v_mfma_f32_16x16x32_bf16 v[216:219], v[20:23], a[224:227], 0
    v_mfma_f32_16x16x32_bf16 v[220:223], v[20:23], a[228:231], 0
    v_mfma_f32_16x16x32_bf16 v[224:227], v[20:23], a[232:235], 0
    s_mov_b64 exec, 0xfffe
    ds_write2_b32 v79, v148, v8 offset0:0 offset1:128
    s_mov_b64 exec, 0x3e
    ds_write2_b32 v34, v152, v9 offset0:0 offset1:128
    s_mov_b64 exec, -1
    v_mfma_f32_16x16x32_bf16 v[228:231], v[20:23], a[236:239], 0
    v_mfma_f32_16x16x32_bf16 v[232:235], v[20:23], a[240:243], 0
    v_mfma_f32_16x16x32_bf16 v[236:239], v[20:23], a[244:247], 0
    s_waitcnt lgkmcnt(0)
    s_barrier
    v_mfma_f32_16x16x32_bf16 v[144:147], a[180:183], a[196:199], v[144:147]
    s_add_u32 m0, s66, 69632
    s_mov_b32 s77, 262144
    ds_read_b32 v7, v79
    buffer_load_dwordx4 v44, s[12:15], s77 offen lds
    ds_read2_b32 v[42:43], v78 offset0:64 offset1:192
    v_mfma_f32_16x16x32_bf16 v[124:127], a[192:195], a[180:183], v[124:127]
    ds_read_b128 v[180:183], v80 offset:256
    v_mov_b32_dpp v208, v212 quad_perm:[0,1,2,3] row_mask:0x2 bank_mask:0xf
    v_mov_b32_dpp v224, v228 quad_perm:[0,1,2,3] row_mask:0x2 bank_mask:0xf
    v_mfma_f32_16x16x32_bf16 v[108:111], a[192:195], a[164:167], v[108:111]
    ds_read_b128 v[200:203], v80 offset:768
    v_mov_b32_dpp v208, v216 quad_perm:[0,1,2,3] row_mask:0x4 bank_mask:0xf
    v_mov_b32_dpp v224, v232 quad_perm:[0,1,2,3] row_mask:0x4 bank_mask:0xf
    v_mfma_f32_16x16x32_bf16 v[112:115], a[192:195], a[168:171], v[112:115]
    ds_read2_b32 v[10:11], v78 offset0:0 offset1:128
    v_mov_b32_dpp v208, v220 quad_perm:[0,1,2,3] row_mask:0x8 bank_mask:0xf
    v_mov_b32_dpp v224, v236 quad_perm:[0,1,2,3] row_mask:0x8 bank_mask:0xf
    v_mfma_f32_16x16x32_bf16 v[116:119], a[192:195], a[172:175], v[116:119]
    ds_read_b128 v[164:167], v80 offset:0
    v_add_f32_dpp v208, v208, v208 row_ror:8 row_mask:0xf bank_mask:0xf
    v_add_f32_dpp v224, v224, v224 row_ror:8 row_mask:0xf bank_mask:0xf
    v_mfma_f32_16x16x32_bf16 v[120:123], a[192:195], a[176:179], v[120:123]
    s_mov_b32 s77, 294912
    ds_read_b128 v[184:187], v80 offset:512
    v_add_f32_dpp v208, v208, v208 row_ror:4 row_mask:0xf bank_mask:0xf
    v_add_f32_dpp v224, v224, v224 row_ror:4 row_mask:0xf bank_mask:0xf
    v_mfma_f32_16x16x32_bf16 v[100:103], a[188:191], a[176:179], v[100:103]
    s_add_u32 m0, s66, 73728
    ds_read2_b32 v[12:13], v78 offset0:16 offset1:144
    buffer_load_dwordx4 v44, s[12:15], s77 offen lds
    v_add_f32_dpp v208, v208, v208 row_ror:2 row_mask:0xf bank_mask:0xf
    v_mfma_f32_16x16x32_bf16 v[96:99], a[188:191], a[172:175], v[96:99]
    ds_read_b128 v[168:171], v80 offset:64
    v_add_f32_dpp v224, v224, v224 row_ror:2 row_mask:0xf bank_mask:0xf
    v_add_f32_dpp v208, v208, v208 row_ror:1 row_mask:0xf bank_mask:0xf
    v_mfma_f32_16x16x32_bf16 v[92:95], a[188:191], a[168:171], v[92:95]
    ds_read_b128 v[188:191], v80 offset:576
    v_add_f32_dpp v224, v224, v224 row_ror:1 row_mask:0xf bank_mask:0xf
    s_nop 1
    v_mov_b32_dpp v208, v224 quad_perm:[0,1,2,3] row_mask:0xf bank_mask:0xa
    v_mfma_f32_16x16x32_bf16 v[88:91], a[188:191], a[164:167], v[88:91]
    ds_read2_b32 v[14:15], v78 offset0:32 offset1:160
    v_mul_f32 v208, 0x3b000000, v208
    v_cvt_pk_bf16_f32 v209, v208, v208
    v_mfma_f32_16x16x32_bf16 v[104:107], a[188:191], v[20:23], v[104:107]
    ds_read_b128 v[172:175], v80 offset:128
    v_and_b32 v210, 0xffff0000, v209
    v_sub_f32 v210, v208, v210
    v_cvt_pk_bf16_f32 v210, v210, v210
    v_mfma_f32_16x16x32_bf16 v[128:131], a[164:167], a[196:199], v[128:131]
    ds_read_b128 v[192:195], v80 offset:640
    v_mov_b32_dpp v209, v210 quad_perm:[0,1,2,3] row_mask:0xf bank_mask:0xc
    v_mov_b32 v86, v144
    v_mov_b32 v87, v144
    v_mfma_f32_16x16x32_bf16 v[132:135], a[168:171], a[196:199], v[132:135]
    ds_read2_b32 v[40:41], v78 offset0:48 offset1:176
    v_mov_b32_dpp v204, v124 row_newbcast:0 row_mask:0xf bank_mask:0xf
    v_mov_b32_dpp v205, v125 row_newbcast:0 row_mask:0xf bank_mask:0xf
    v_mov_b32_dpp v206, v126 row_newbcast:0 row_mask:0xf bank_mask:0xf
    v_mfma_f32_16x16x32_bf16 v[136:139], a[172:175], a[196:199], v[136:139]
    ds_read_b128 v[176:179], v80 offset:192
    v_mov_b32_dpp v207, v127 row_newbcast:0 row_mask:0xf bank_mask:0xf
    v_permlane16_swap_b32 v86, v87
    v_mfma_f32_16x16x32_bf16 v[140:143], a[176:179], a[196:199], v[140:143]
    s_waitcnt lgkmcnt(12)
    ds_read_b128 v[196:199], v80 offset:704
    v_mov_b32 v87, v86
    s_nop 1
    v_permlane32_swap_b32 v86, v87
    s_lshl4_add_u32 s73, s3, s89
    s_mov_b64 exec, s[36:37]
    buffer_store_short v209, v84, s[32:35], s73 offen
    s_mov_b64 exec, -1
    s_nop 0
    s_waitcnt lgkmcnt(0)
    s_add_u32 m0, s66, 77824
    s_mov_b32 s77, 327680
    buffer_load_dwordx4 v44, s[12:15], s77 offen lds
    v_mul_f32 v232, 0x3eb8aa3b, v11
    v_mul_f32 v234, 0x3eb8aa3b, v13
    v_mul_f32 v236, 0x3eb8aa3b, v15
    v_mul_f32 v238, 0x3eb8aa3b, v41
    v_pk_fma_f32 v[124:125], v[42:43], v[204:205], v[124:125] op_sel_hi:[0,1,1]
    v_pk_fma_f32 v[126:127], v[42:43], v[206:207], v[126:127] op_sel_hi:[0,1,1]
    v_pk_mul_f32 v[124:125], v[124:125], v[42:43] op_sel:[0,1] op_sel_hi:[1,1]
    v_pk_mul_f32 v[126:127], v[126:127], v[42:43] op_sel:[0,1] op_sel_hi:[1,1]
    v_pk_fma_f32 v[144:145], v[180:181], v[86:87], v[144:145] op_sel_hi:[1,0,1]
    v_pk_fma_f32 v[146:147], v[182:183], v[86:87], v[146:147] op_sel_hi:[1,0,1]
    v_pk_mul_f32 v[144:145], v[144:145], v[200:201]
    v_pk_mul_f32 v[146:147], v[146:147], v[202:203]
    s_add_u32 m0, s66, 81920
    s_mov_b32 s77, 360448
    buffer_load_dwordx4 v44, s[12:15], s77 offen lds
    v_pk_fma_f32 v[108:109], v[10:11], v[204:205], v[108:109] op_sel_hi:[0,1,1]
    v_pk_fma_f32 v[110:111], v[10:11], v[206:207], v[110:111] op_sel_hi:[0,1,1]
    v_pk_fma_f32 v[88:89], v[10:11], v[104:105], v[88:89] op_sel_hi:[0,1,1]
    v_pk_fma_f32 v[90:91], v[10:11], v[106:107], v[90:91] op_sel_hi:[0,1,1]
    v_pk_mul_f32 v[108:109], v[108:109], v[10:11] op_sel:[0,1] op_sel_hi:[1,1]
    v_pk_mul_f32 v[110:111], v[110:111], v[10:11] op_sel:[0,1] op_sel_hi:[1,1]
    v_pk_fma_f32 v[128:129], v[164:165], v[86:87], v[128:129] op_sel_hi:[1,0,1]
    v_pk_fma_f32 v[130:131], v[166:167], v[86:87], v[130:131] op_sel_hi:[1,0,1]
    v_pk_mul_f32 v[128:129], v[128:129], v[184:185]
    v_pk_mul_f32 v[130:131], v[130:131], v[186:187]
    v_pk_fma_f32 v[112:113], v[12:13], v[204:205], v[112:113] op_sel_hi:[0,1,1]
    v_pk_fma_f32 v[114:115], v[12:13], v[206:207], v[114:115] op_sel_hi:[0,1,1]
    s_add_u32 m0, s66, 86016
    s_mov_b32 s77, 393216
    buffer_load_dwordx4 v44, s[12:15], s77 offen lds
    v_pk_fma_f32 v[92:93], v[12:13], v[104:105], v[92:93] op_sel_hi:[0,1,1]
    v_pk_fma_f32 v[94:95], v[12:13], v[106:107], v[94:95] op_sel_hi:[0,1,1]
    v_pk_mul_f32 v[112:113], v[112:113], v[12:13] op_sel:[0,1] op_sel_hi:[1,1]
    v_pk_mul_f32 v[114:115], v[114:115], v[12:13] op_sel:[0,1] op_sel_hi:[1,1]
    v_pk_fma_f32 v[132:133], v[168:169], v[86:87], v[132:133] op_sel_hi:[1,0,1]
    v_pk_fma_f32 v[134:135], v[170:171], v[86:87], v[134:135] op_sel_hi:[1,0,1]
    v_pk_mul_f32 v[132:133], v[132:133], v[188:189]
    v_pk_mul_f32 v[134:135], v[134:135], v[190:191]
    v_pk_fma_f32 v[116:117], v[14:15], v[204:205], v[116:117] op_sel_hi:[0,1,1]
    v_pk_fma_f32 v[118:119], v[14:15], v[206:207], v[118:119] op_sel_hi:[0,1,1]
    v_pk_fma_f32 v[96:97], v[14:15], v[104:105], v[96:97] op_sel_hi:[0,1,1]
    v_pk_fma_f32 v[98:99], v[14:15], v[106:107], v[98:99] op_sel_hi:[0,1,1]
    v_pk_mul_f32 v[116:117], v[116:117], v[14:15] op_sel:[0,1] op_sel_hi:[1,1]
    s_add_u32 m0, s66, 90112
    s_mov_b32 s77, 425984
    buffer_load_dwordx4 v44, s[12:15], s77 offen lds
    v_pk_mul_f32 v[118:119], v[118:119], v[14:15] op_sel:[0,1] op_sel_hi:[1,1]
    v_pk_fma_f32 v[136:137], v[172:173], v[86:87], v[136:137] op_sel_hi:[1,0,1]
    v_pk_fma_f32 v[138:139], v[174:175], v[86:87], v[138:139] op_sel_hi:[1,0,1]
    v_pk_mul_f32 v[136:137], v[136:137], v[192:193]
    v_pk_mul_f32 v[138:139], v[138:139], v[194:195]
    v_pk_fma_f32 v[120:121], v[40:41], v[204:205], v[120:121] op_sel_hi:[0,1,1]
    v_pk_fma_f32 v[122:123], v[40:41], v[206:207], v[122:123] op_sel_hi:[0,1,1]
    v_pk_fma_f32 v[100:101], v[40:41], v[104:105], v[100:101] op_sel_hi:[0,1,1]
    v_pk_fma_f32 v[102:103], v[40:41], v[106:107], v[102:103] op_sel_hi:[0,1,1]
    v_pk_mul_f32 v[120:121], v[120:121], v[40:41] op_sel:[0,1] op_sel_hi:[1,1]
    v_pk_mul_f32 v[122:123], v[122:123], v[40:41] op_sel:[0,1] op_sel_hi:[1,1]
    v_pk_fma_f32 v[140:141], v[176:177], v[86:87], v[140:141] op_sel_hi:[1,0,1]
    s_add_u32 m0, s66, 4096
    s_mov_b32 s77, 458752
    buffer_load_dwordx4 v44, s[12:15], s77 offen lds
    v_pk_fma_f32 v[142:143], v[178:179], v[86:87], v[142:143] op_sel_hi:[1,0,1]
    v_pk_mul_f32 v[140:141], v[140:141], v[196:197]
    v_pk_mul_f32 v[142:143], v[142:143], v[198:199]
    v_cvt_pk_bf16_f32 v18, v88, v89
    v_cvt_pk_bf16_f32 v19, v90, v91
    v_cvt_pk_bf16_f32 v34, v108, v109
    v_cvt_pk_bf16_f32 v35, v110, v111
    v_cvt_pk_bf16_f32 v212, v124, v125
    v_cvt_pk_bf16_f32 v213, v126, v127
    v_mfma_f32_16x16x16_bf16 v[164:167], v[34:35], v[18:19], v[52:55]
    v_cvt_pk_bf16_f32 v24, v92, v93
    v_cvt_pk_bf16_f32 v25, v94, v95
    v_mfma_f32_16x16x16_bf16 v[184:187], v[212:213], v[18:19], v[60:63]
    s_add_u32 m0, s66, 8192
    s_mov_b32 s77, 491520
    buffer_load_dwordx4 v44, s[12:15], s77 offen lds
    v_cvt_pk_bf16_f32 v38, v112, v113
    v_cvt_pk_bf16_f32 v39, v114, v115
    v_mfma_f32_16x16x16_bf16 v[188:191], v[34:35], v[24:25], v[56:59]
    v_cvt_pk_bf16_f32 v26, v96, v97
    v_cvt_pk_bf16_f32 v27, v98, v99
    v_mfma_f32_16x16x16_bf16 v[168:171], v[38:39], v[24:25], v[52:55]
    v_cvt_pk_bf16_f32 v208, v116, v117
    v_cvt_pk_bf16_f32 v209, v118, v119
    v_mfma_f32_16x16x16_bf16 v[192:195], v[212:213], v[26:27], v[64:67]
    v_cvt_pk_bf16_f32 v28, v100, v101
    v_cvt_pk_bf16_f32 v29, v102, v103
    v_mfma_f32_16x16x16_bf16 v[172:175], v[208:209], v[26:27], v[52:55]
    s_add_u32 m0, s66, 12288
    s_nop 0
    buffer_load_dwordx4 v46, s[16:19], s48 offen lds
    v_cvt_pk_bf16_f32 v210, v120, v121
    v_cvt_pk_bf16_f32 v211, v122, v123
    v_mfma_f32_16x16x16_bf16 v[196:199], v[208:209], v[28:29], v[56:59]
    v_cvt_pk_bf16_f32 v218, v144, v145
    v_cvt_pk_bf16_f32 v219, v146, v147
    v_mfma_f32_16x16x16_bf16 v[176:179], v[210:211], v[28:29], v[52:55]
    v_cvt_pk_bf16_f32 v216, v128, v129
    v_cvt_pk_bf16_f32 v217, v130, v131
    v_cvt_pk_bf16_f32 v214, v132, v133
    v_cvt_pk_bf16_f32 v215, v134, v135
    v_cvt_pk_bf16_f32 v220, v136, v137
    v_cvt_pk_bf16_f32 v221, v138, v139
    s_add_u32 m0, s66, 16320
    s_nop 0
    buffer_load_dwordx4 v48, s[16:19], s48 offen offset:64 lds
    v_cvt_pk_bf16_f32 v222, v140, v141
    v_cvt_pk_bf16_f32 v223, v142, v143
    v_max_f32 v164, v164, v184
    v_max_f32 v165, v165, v185
    v_max_f32 v166, v166, v186
    v_max_f32 v167, v167, v187
    v_max3_f32 v224, v164, v165, v166
    v_max_f32 v225, v224, v167
    v_max_f32 v224, v224, v167
    v_max_f32 v168, v168, v188
    v_max_f32 v169, v169, v189
    v_max_f32 v170, v170, v190
    v_max_f32 v171, v171, v191
    s_add_u32 m0, s66, 20352
    s_nop 0
    buffer_load_dwordx4 v48, s[16:19], s48 offen offset:128 lds
    v_max3_f32 v226, v168, v169, v170
    v_max_f32 v227, v226, v171
    v_max_f32 v226, v226, v171
    v_max_f32 v172, v172, v192
    v_max_f32 v173, v173, v193
    v_max_f32 v174, v174, v194
    v_max_f32 v175, v175, v195
    v_max3_f32 v228, v172, v173, v174
    v_max_f32 v229, v228, v175
    v_max_f32 v228, v228, v175
    v_max_f32 v176, v176, v196
    v_max_f32 v177, v177, v197
    s_add_u32 m0, s66, 94208
    s_nop 0
    buffer_load_dwordx4 v47, s[16:19], s48 offen lds
    v_max_f32 v178, v178, v198
    v_max_f32 v179, v179, v199
    v_max3_f32 v230, v176, v177, v178
    v_max_f32 v231, v230, v179
    v_max_f32 v230, v230, v179
    v_permlane16_swap_b32 v224, v225
    v_permlane16_swap_b32 v226, v227
    v_permlane16_swap_b32 v228, v229
    v_permlane16_swap_b32 v230, v231
    v_max_f32 v233, v224, v225
    v_max_f32 v224, v224, v225
    v_max_f32 v235, v226, v227
    v_max_f32 v226, v226, v227
    s_add_u32 m0, s66, 98240
    s_nop 0
    buffer_load_dwordx4 v49, s[16:19], s48 offen offset:64 lds
    v_max_f32 v237, v228, v229
    v_max_f32 v228, v228, v229
    v_max_f32 v239, v230, v231
    v_max_f32 v230, v230, v231
    v_permlane32_swap_b32 v224, v233
    v_permlane32_swap_b32 v226, v235
    v_permlane32_swap_b32 v228, v237
    v_permlane32_swap_b32 v230, v239
    v_max_f32 v224, v224, v233
    v_max_f32 v226, v226, v235
    v_max_f32 v228, v228, v237
    v_max_f32 v230, v230, v239
    s_add_u32 m0, s66, 102272
    s_nop 0
    buffer_load_dwordx4 v49, s[16:19], s48 offen offset:128 lds
    v_mul_f32_e64 v233, v224, v232
    v_pk_fma_f32 v[164:165], v[164:165], v[232:233], v[232:233] op_sel:[0,0,1] op_sel_hi:[1,0,1] neg_lo:[0,0,1] neg_hi:[0,0,1]
    v_pk_fma_f32 v[166:167], v[166:167], v[232:233], v[232:233] op_sel:[0,0,1] op_sel_hi:[1,0,1] neg_lo:[0,0,1] neg_hi:[0,0,1]
    v_mul_f32_e64 v235, v226, v234
    v_pk_fma_f32 v[168:169], v[168:169], v[234:235], v[234:235] op_sel:[0,0,1] op_sel_hi:[1,0,1] neg_lo:[0,0,1] neg_hi:[0,0,1]
    v_pk_fma_f32 v[170:171], v[170:171], v[234:235], v[234:235] op_sel:[0,0,1] op_sel_hi:[1,0,1] neg_lo:[0,0,1] neg_hi:[0,0,1]
    v_mul_f32_e64 v237, v228, v236
    v_pk_fma_f32 v[172:173], v[172:173], v[236:237], v[236:237] op_sel:[0,0,1] op_sel_hi:[1,0,1] neg_lo:[0,0,1] neg_hi:[0,0,1]
    v_pk_fma_f32 v[174:175], v[174:175], v[236:237], v[236:237] op_sel:[0,0,1] op_sel_hi:[1,0,1] neg_lo:[0,0,1] neg_hi:[0,0,1]
    v_mul_f32_e64 v239, v230, v238
    v_pk_fma_f32 v[176:177], v[176:177], v[238:239], v[238:239] op_sel:[0,0,1] op_sel_hi:[1,0,1] neg_lo:[0,0,1] neg_hi:[0,0,1]
    v_pk_fma_f32 v[178:179], v[178:179], v[238:239], v[238:239] op_sel:[0,0,1] op_sel_hi:[1,0,1] neg_lo:[0,0,1] neg_hi:[0,0,1]
    v_exp_f32 v164, v164
    v_exp_f32 v165, v165
    v_exp_f32 v166, v166
    v_exp_f32 v167, v167
    v_exp_f32_e64 v168, v168
    v_cvt_pk_bf16_f32 v224, v164, v165
    v_cvt_pk_bf16_f32 v225, v166, v167
    v_and_b32 v88, v224, v50
    v_and_b32 v89, v225, v51
    v_mfma_f32_16x16x16_bf16 v[184:187], v[20:21], v[224:225], 0
    v_xor_b32 v90, v224, v88
    v_xor_b32 v91, v225, v89
    v_exp_f32 v169, v169
    s_nop 0
    v_mfma_f32_16x16x32_bf16 v[128:131], v[216:219], v[88:91], 0
    v_exp_f32 v170, v170
    v_exp_f32 v171, v171
    v_exp_f32_e64 v172, v172
    v_cvt_pk_bf16_f32 v226, v168, v169
    v_cvt_pk_bf16_f32 v227, v170, v171
    v_and_b32 v92, v226, v50
    v_and_b32 v93, v227, v51
    v_mfma_f32_16x16x16_bf16 v[188:191], v[20:21], v[226:227], 0
    v_xor_b32 v94, v226, v92
    v_xor_b32 v95, v227, v93
    v_exp_f32 v173, v173
    s_nop 0
    v_mfma_f32_16x16x32_bf16 v[132:135], v[214:217], v[92:95], 0
    v_exp_f32 v174, v174
    v_exp_f32 v175, v175
    v_exp_f32_e64 v176, v176
    v_cvt_pk_bf16_f32 v228, v172, v173
    v_cvt_pk_bf16_f32 v229, v174, v175
    v_and_b32 v98, v228, v50
    v_and_b32 v99, v229, v51
    v_mfma_f32_16x16x16_bf16 v[192:195], v[20:21], v[228:229], 0
    v_xor_b32 v96, v228, v98
    v_xor_b32 v97, v229, v99
    v_exp_f32 v177, v177
    s_nop 0
    v_mfma_f32_16x16x32_bf16 v[136:139], v[218:221], v[96:99], 0
    v_exp_f32 v178, v178
    v_exp_f32 v179, v179
    v_rcp_f32_e64 v184, v184
    v_cvt_pk_bf16_f32 v230, v176, v177
    v_cvt_pk_bf16_f32 v231, v178, v179
    v_and_b32 v102, v230, v50
    v_and_b32 v103, v231, v51
    v_mfma_f32_16x16x16_bf16 v[196:199], v[20:21], v[230:231], 0
    v_xor_b32 v100, v230, v102
    v_xor_b32 v101, v231, v103
    v_rcp_f32 v188, v188
    s_nop 0
    v_mfma_f32_16x16x32_bf16 v[140:143], v[220:223], v[100:103], 0
    s_add_u32 s74, s86, 32768
    v_mul_f32 v128, v128, v184
    v_mul_f32 v129, v129, v184
    v_mul_f32 v130, v130, v184
    v_mul_f32 v131, v131, v184
    v_cvt_pk_bf16_f32 v108, v128, v129
    v_cvt_pk_bf16_f32 v109, v130, v131
    v_mul_f32 v132, v132, v188
    v_mul_f32 v133, v133, v188
    v_mul_f32 v134, v134, v188
    v_mul_f32 v135, v135, v188
    v_cvt_pk_bf16_f32 v110, v132, v133
    v_cvt_pk_bf16_f32 v111, v134, v135
    v_rcp_f32 v192, v192
    v_rcp_f32 v196, v196
    v_permlane16_swap_b32 v108, v110
    v_permlane16_swap_b32 v109, v111
    buffer_store_dwordx4 v[108:111], v82, s[32:35], s86 offen
    v_pk_mul_f32 v[136:137], v[136:137], v[192:193] op_sel_hi:[1,0]
    v_pk_mul_f32 v[138:139], v[138:139], v[192:193] op_sel_hi:[1,0]
    v_cvt_pk_bf16_f32 v112, v136, v137
    v_cvt_pk_bf16_f32 v113, v138, v139
    v_pk_mul_f32 v[140:141], v[140:141], v[196:197] op_sel_hi:[1,0]
    v_pk_mul_f32 v[142:143], v[142:143], v[196:197] op_sel_hi:[1,0]
    v_cvt_pk_bf16_f32 v114, v140, v141
    v_cvt_pk_bf16_f32 v115, v142, v143
    s_nop 0
    v_permlane16_swap_b32 v112, v114
    v_permlane16_swap_b32 v113, v115
    buffer_store_dwordx4 v[112:115], v82, s[32:35], s74 offen
    s_waitcnt vmcnt(8)
    s_barrier
    v_xor_b32 v13, 32, v75
    v_xor_b32_e64 v14, 64, v75
    v_xor_b32 v15, 96, v75
    v_add_u32 v16, 65536, v75
    v_add_u32 v18, 131072, v75
    v_add_u32 v19, 65536, v13
    v_add_u32 v24, 131072, v13
    v_add_u32 v25, 65536, v14
    v_add_u32 v26, 131072, v14
    v_add_u32 v27, 65536, v15
    v_add_u32 v28, 131072, v15
    ds_read_b64_tr_b16 a[0:1], v18 offset:0
    s_add_u32 m0, s66, 106496
    s_nop 0
    buffer_load_dwordx4 v46, s[16:19], s49 offen lds
    ds_read_b64_tr_b16 a[2:3], v18 offset:1024
    ds_read_b64_tr_b16 a[4:5], v24 offset:0
    s_add_u32 m0, s66, 110528
    s_nop 0
    buffer_load_dwordx4 v48, s[16:19], s49 offen offset:64 lds
    ds_read_b64_tr_b16 a[6:7], v24 offset:1024
    ds_read_b64_tr_b16 a[8:9], v26 offset:0
    ds_read_b64_tr_b16 a[10:11], v26 offset:1024
    s_add_u32 m0, s66, 114560
    s_nop 0
    buffer_load_dwordx4 v48, s[16:19], s49 offen offset:128 lds
    ds_read_b64_tr_b16 a[12:13], v28 offset:0
    ds_read_b64_tr_b16 a[14:15], v28 offset:1024
    v_lshlrev_b32 v52, 16, v156
    v_and_b32 v53, 0xffff0000, v156
    v_lshlrev_b32 v54, 16, v157
    v_and_b32 v55, 0xffff0000, v157
    v_lshlrev_b32 v56, 16, v158
    v_and_b32 v57, 0xffff0000, v158
    v_lshlrev_b32 v58, 16, v159
    v_and_b32 v59, 0xffff0000, v159
    v_lshlrev_b32 v60, 16, v160
    v_and_b32 v61, 0xffff0000, v160
    v_lshlrev_b32 v62, 16, v161
    v_and_b32 v63, 0xffff0000, v161
    v_lshlrev_b32 v64, 16, v162
    v_and_b32 v65, 0xffff0000, v162
    v_lshlrev_b32 v66, 16, v163
    v_and_b32 v67, 0xffff0000, v163
    v_cmp_eq_u32 vcc, 0, v85
    s_nop 0
    s_cbranch_vccnz L_regpoll_3
L_regok_4:
    s_waitcnt vmcnt(3)
    s_cmp_lg_u32 s60, 0
    s_cbranch_scc1 L_slowsig_5
    s_mov_b64 exec, 1
    buffer_store_dword v74, v69, s[32:35], 0 offen
    s_mov_b64 exec, -1
L_sigback_6:
    ds_read_b64_tr_b16 a[16:17], v18 offset:4096
    ds_read_b64_tr_b16 a[18:19], v18 offset:5120
    ds_read_b64_tr_b16 a[20:21], v24 offset:4096
    ds_read_b64_tr_b16 a[22:23], v24 offset:5120
    ds_read_b64_tr_b16 a[24:25], v26 offset:4096
    ds_read_b64_tr_b16 a[26:27], v26 offset:5120
    ds_read_b64_tr_b16 a[28:29], v28 offset:4096
    s_waitcnt lgkmcnt(12)
    ds_read_b64_tr_b16 a[30:31], v28 offset:5120
    ds_read_b64_tr_b16 a[32:33], v18 offset:8192
    ds_read_b64_tr_b16 a[34:35], v18 offset:9216
    s_waitcnt lgkmcnt(12)
    ds_read_b64_tr_b16 a[36:37], v24 offset:8192
    ds_read_b64_tr_b16 a[38:39], v24 offset:9216
    ds_read_b64_tr_b16 a[40:41], v26 offset:8192
    s_waitcnt lgkmcnt(12)
    ds_read_b64_tr_b16 a[42:43], v26 offset:9216
    ds_read_b64_tr_b16 a[44:45], v28 offset:8192
    ds_read_b64_tr_b16 a[46:47], v28 offset:9216
    s_waitcnt lgkmcnt(0)
    s_barrier
    buffer_load_dword v10, v71, s[32:35], 0 offen offset:0 sc1
    s_add_u32 m0, s66, 118784
    s_nop 0
    buffer_load_dwordx4 v47, s[16:19], s49 offen lds
    s_add_u32 m0, s66, 122816
    s_nop 0
    buffer_load_dwordx4 v49, s[16:19], s49 offen offset:64 lds
    s_add_u32 m0, s66, 126848
    s_nop 0
    s_nop 0
    buffer_load_dwordx4 v49, s[16:19], s49 offen offset:128 lds
    ds_read_b64_tr_b16 a[48:49], v18 offset:12288
    ds_read_b64_tr_b16 a[50:51], v18 offset:13312
    ds_read_b64_tr_b16 a[52:53], v24 offset:12288
    ds_read_b64_tr_b16 a[54:55], v24 offset:13312
    ds_read_b64_tr_b16 a[56:57], v26 offset:12288
    ds_read_b64_tr_b16 a[58:59], v26 offset:13312
    ds_read_b64_tr_b16 a[60:61], v28 offset:12288
    ds_read_b64_tr_b16 a[62:63], v28 offset:13312
    ds_read_b64_tr_b16 a[64:65], v18 offset:16384
    ds_read_b64_tr_b16 a[66:67], v18 offset:17408
    ds_read_b64_tr_b16 a[68:69], v24 offset:16384
    ds_read_b64_tr_b16 a[70:71], v24 offset:17408
    ds_read_b64_tr_b16 a[72:73], v26 offset:16384
    ds_read_b64_tr_b16 a[74:75], v26 offset:17408
    ds_read_b64_tr_b16 a[76:77], v28 offset:16384
    s_waitcnt lgkmcnt(12)
    ds_read_b64_tr_b16 a[78:79], v28 offset:17408
    ds_read_b64_tr_b16 a[80:81], v18 offset:20480
    ds_read_b64_tr_b16 a[82:83], v18 offset:21504
    s_waitcnt lgkmcnt(12)
    ds_read_b64_tr_b16 a[84:85], v24 offset:20480
    ds_read_b64_tr_b16 a[86:87], v24 offset:21504
    ds_read_b64_tr_b16 a[88:89], v26 offset:20480
    s_waitcnt lgkmcnt(12)
    ds_read_b64_tr_b16 a[90:91], v26 offset:21504
    ds_read_b64_tr_b16 a[92:93], v28 offset:20480
    ds_read_b64_tr_b16 a[94:95], v28 offset:21504
    s_waitcnt lgkmcnt(12)
    ds_read_b64_tr_b16 a[96:97], v18 offset:24576
    ds_read_b64_tr_b16 a[98:99], v18 offset:25600
    ds_read_b64_tr_b16 a[100:101], v24 offset:24576
    s_waitcnt lgkmcnt(12)
    ds_read_b64_tr_b16 a[102:103], v24 offset:25600
    ds_read_b64_tr_b16 a[104:105], v26 offset:24576
    ds_read_b64_tr_b16 a[106:107], v26 offset:25600
    s_waitcnt lgkmcnt(12)
    ds_read_b64_tr_b16 a[108:109], v28 offset:24576
    ds_read_b64_tr_b16 a[110:111], v28 offset:25600
    ds_read_b64_tr_b16 a[112:113], v18 offset:28672
    s_waitcnt lgkmcnt(12)
    ds_read_b64_tr_b16 a[114:115], v18 offset:29696
L_warm_2:
    s_cbranch_execz L_warm_6
    ds_read_b64_tr_b16 a[116:117], v24 offset:28672
    ds_read_b64_tr_b16 a[118:119], v24 offset:29696
    s_waitcnt lgkmcnt(12)
    ds_read_b64_tr_b16 a[120:121], v26 offset:28672
    ds_read_b64_tr_b16 a[122:123], v26 offset:29696
    ds_read_b64_tr_b16 a[124:125], v28 offset:28672
    s_waitcnt lgkmcnt(12)
    ds_read_b64_tr_b16 a[126:127], v28 offset:29696
    buffer_load_dword v11, v71, s[32:35], 0 offen offset:0 sc1
    v_xor_b32_e64 v8, 32, v76
    v_add_u32 v9, 65536, v76
    v_add_u32 v29, 131072, v76
    v_add_u32 v30, 65536, v8
    v_add_u32 v33, 131072, v8
    s_lshl2_add_u32 s73, s69, s3
    s_lshl_b32 s73, s73, 14
    s_add_u32 s73, s73, s72
    v_add_u32 v34, s73, v17
    v_lshlrev_b32 v3, 3, v0
    s_min_u32 s74, s66, 2048
    s_branch L_poll_7_o
L_poll_7:
    s_mov_b32 s79, 0
    s_cmp_lg_u32 s60, 0
    s_cbranch_scc1 L_poll_7_s
    s_waitcnt vmcnt(0)
    v_cmp_ne_u32 vcc, s78, v11
    s_nop 0
    s_cbranch_vccz L_pollback_8
L_poll_7_l:
    buffer_load_dword v10, v71, s[32:35], 0 offen offset:0 sc1
    s_add_u32 s79, s79, 1
    s_waitcnt vmcnt(0)
    v_cmp_ne_u32 vcc, s78, v10
    s_nop 0
    s_cbranch_vccz L_pollback_8
    s_cmp_lt_u32 s79, 200
    s_cbranch_scc1 L_poll_7_l
    s_branch L_poll_7_t
L_poll_7_o:
    s_waitcnt vmcnt(4)
    v_cmp_ne_u32 vcc, s78, v10
    s_nop 0
    s_or_b64 s[56:57], vcc, s[60:61]
    s_cbranch_scc1 L_poll_7
L_pollback_8:
    s_mov_b32 s82, 0
    buffer_load_dwordx4 v[112:115], v34, s[32:35], s82 offen offset:0 sc1
    buffer_load_dwordx4 v[116:119], v34, s[32:35], s82 offen offset:1024 sc1
    buffer_load_dwordx4 v[120:123], v34, s[32:35], s82 offen offset:2048 sc1
    s_add_u32 m0, s74, 1024
    s_nop 0
    buffer_load_dwordx4 v81, s[32:35], 0 offen sc1 lds
    buffer_load_dwordx4 v[124:127], v34, s[32:35], s82 offen offset:3072 sc1
    s_mov_b32 s82, 4096
    buffer_load_dwordx4 v[128:131], v34, s[32:35], s82 offen offset:0 sc1
    buffer_load_dwordx4 v[132:135], v34, s[32:35], s82 offen offset:1024 sc1
    buffer_load_dwordx4 v[136:139], v34, s[32:35], s82 offen offset:2048 sc1
    buffer_load_dwordx4 v[140:143], v34, s[32:35], s82 offen offset:3072 sc1
    s_waitcnt vmcnt(8)
    v_mfma_f32_16x16x32_bf16 v[52:55], a[0:3], v[112:115], v[52:55]
    s_mov_b32 s82, 8192
    ds_read_b64_tr_b16 a[128:129], v16 offset:4096
    buffer_load_dwordx4 v[144:147], v34, s[32:35], s82 offen offset:0 sc1
    ds_read_b64_tr_b16 a[130:131], v16 offset:5120
    v_mfma_f32_16x16x32_bf16 v[56:59], a[4:7], v[112:115], v[56:59]
    s_waitcnt lgkmcnt(12)
    ds_read_b64_tr_b16 a[132:133], v19 offset:4096
    v_mfma_f32_16x16x32_bf16 v[60:63], a[8:11], v[112:115], v[60:63]
    ds_read_b64_tr_b16 a[134:135], v19 offset:5120
    v_mfma_f32_16x16x32_bf16 v[64:67], a[12:15], v[112:115], v[64:67]
    s_waitcnt vmcnt(8)
    ds_read_b64_tr_b16 a[136:137], v25 offset:4096
    v_mfma_f32_16x16x32_bf16 v[52:55], a[16:19], v[116:119], v[52:55]
    s_waitcnt lgkmcnt(12)
    ds_read_b64_tr_b16 a[138:139], v25 offset:5120
    buffer_load_dwordx4 v[148:151], v34, s[32:35], s82 offen offset:1024 sc1
    ds_read_b64_tr_b16 a[140:141], v27 offset:4096
    v_mfma_f32_16x16x32_bf16 v[56:59], a[20:23], v[116:119], v[56:59]
    ds_read_b64_tr_b16 a[142:143], v27 offset:5120
    v_mfma_f32_16x16x32_bf16 v[60:63], a[24:27], v[116:119], v[60:63]
    s_waitcnt lgkmcnt(12)
    ds_read_b64_tr_b16 a[144:145], v16 offset:8192
    v_mfma_f32_16x16x32_bf16 v[64:67], a[28:31], v[116:119], v[64:67]
    s_waitcnt vmcnt(8)
    ds_read_b64_tr_b16 a[146:147], v16 offset:9216
    v_mfma_f32_16x16x32_bf16 v[52:55], a[32:35], v[120:123], v[52:55]
    ds_read_b64_tr_b16 a[148:149], v19 offset:8192
    buffer_load_dwordx4 v[152:155], v34, s[32:35], s82 offen offset:2048 sc1
    s_waitcnt lgkmcnt(12)
    ds_read_b64_tr_b16 a[150:151], v19 offset:9216
    v_mfma_f32_16x16x32_bf16 v[56:59], a[36:39], v[120:123], v[56:59]
    ds_read_b64_tr_b16 a[152:153], v25 offset:8192
    v_mfma_f32_16x16x32_bf16 v[60:63], a[40:43], v[120:123], v[60:63]
    ds_read_b64_tr_b16 a[154:155], v25 offset:9216
    v_mfma_f32_16x16x32_bf16 v[64:67], a[44:47], v[120:123], v[64:67]
    s_waitcnt vmcnt(7)
    s_waitcnt lgkmcnt(12)
    ds_read_b64_tr_b16 a[156:157], v27 offset:8192
    s_barrier
    v_mfma_f32_16x16x32_bf16 v[52:55], a[48:51], v[124:127], v[52:55]
    ds_read_b128 v[88:91], v77 offset:1024
    buffer_load_dwordx4 v[156:159], v34, s[32:35], s82 offen offset:3072 sc1
    ds_read_b128 v[92:95], v77 offset:1088
    v_mfma_f32_16x16x32_bf16 v[56:59], a[52:55], v[124:127], v[56:59]
    s_waitcnt lgkmcnt(12)
    ds_read_b64_tr_b16 a[158:159], v27 offset:9216
    ds_read_b64_tr_b16 a[160:161], v16 offset:12288
    v_mfma_f32_16x16x32_bf16 v[60:63], a[56:59], v[124:127], v[60:63]
    ds_read_b64_tr_b16 a[162:163], v16 offset:13312
    s_waitcnt lgkmcnt(12)
    ds_read_b64_tr_b16 a[164:165], v19 offset:12288
    v_mfma_f32_16x16x32_bf16 v[64:67], a[60:63], v[124:127], v[64:67]
    s_waitcnt vmcnt(7)
    ds_read_b64_tr_b16 a[166:167], v19 offset:13312
    v_mfma_f32_16x16x32_bf16 v[52:55], a[64:67], v[128:131], v[52:55]
    s_mov_b32 s82, 12288
    ds_read_b128 v[96:99], v77 offset:1152
    buffer_load_dwordx4 v[160:163], v34, s[32:35], s82 offen offset:0 sc1
    s_waitcnt lgkmcnt(12)
    ds_read_b64_tr_b16 a[168:169], v25 offset:12288
    v_mfma_f32_16x16x32_bf16 v[56:59], a[68:71], v[128:131], v[56:59]
    ds_read_b64_tr_b16 a[170:171], v25 offset:13312
    ds_read_b64_tr_b16 a[172:173], v27 offset:12288
    v_mfma_f32_16x16x32_bf16 v[60:63], a[72:75], v[128:131], v[60:63]
    s_waitcnt lgkmcnt(12)
    ds_read_b64_tr_b16 a[174:175], v27 offset:13312
    v_mfma_f32_16x16x32_bf16 v[64:67], a[76:79], v[128:131], v[64:67]
    s_waitcnt vmcnt(7) lgkmcnt(10)
    ds_read_b64_tr_b16 a[176:177], v16 offset:16384
    v_mfma_f32_16x16x32_bf16 v[40:43], v[88:91], v[112:115], 0
    ds_read_b128 v[100:103], v77 offset:1216
    buffer_load_dwordx4 v[164:167], v34, s[32:35], s82 offen offset:1024 sc1
    ds_read_b128 v[104:107], v77 offset:1280
    v_mfma_f32_16x16x32_bf16 v[40:43], v[92:95], v[116:119], v[40:43]
    ds_read_b64_tr_b16 a[178:179], v16 offset:17408
    v_mfma_f32_16x16x32_bf16 v[52:55], a[80:83], v[132:135], v[52:55]
    ds_read_b64_tr_b16 a[180:181], v19 offset:16384
    v_mfma_f32_16x16x32_bf16 v[56:59], a[84:87], v[132:135], v[56:59]
    s_waitcnt lgkmcnt(12)
    ds_read_b64_tr_b16 a[182:183], v19 offset:17408
    v_mfma_f32_16x16x32_bf16 v[60:63], a[88:91], v[132:135], v[60:63]
    ds_read_b64_tr_b16 a[184:185], v25 offset:16384
    v_mfma_f32_16x16x32_bf16 v[64:67], a[92:95], v[132:135], v[64:67]
    s_waitcnt vmcnt(7) lgkmcnt(11)
    ds_read_b64_tr_b16 a[186:187], v25 offset:17408
    v_mfma_f32_16x16x32_bf16 v[40:43], v[96:99], v[120:123], v[40:43]
    ds_read_b128 v[108:111], v77 offset:1344
    buffer_load_dwordx4 v[168:171], v34, s[32:35], s82 offen offset:2048 sc1
    ds_read_b64_tr_b16 a[188:189], v27 offset:16384
    v_mfma_f32_16x16x32_bf16 v[52:55], a[96:99], v[136:139], v[52:55]
    ds_read_b64_tr_b16 a[190:191], v27 offset:17408
    v_mfma_f32_16x16x32_bf16 v[56:59], a[100:103], v[136:139], v[56:59]
    s_waitcnt lgkmcnt(12)
    ds_read_b64_tr_b16 a[192:193], v16 offset:20480
    v_mfma_f32_16x16x32_bf16 v[60:63], a[104:107], v[136:139], v[60:63]
    ds_read_b64_tr_b16 a[194:195], v16 offset:21504
    v_mfma_f32_16x16x32_bf16 v[64:67], a[108:111], v[136:139], v[64:67]
    s_waitcnt vmcnt(7) lgkmcnt(10)
    ds_read_b64_tr_b16 a[196:197], v19 offset:20480
    v_mfma_f32_16x16x32_bf16 v[40:43], v[100:103], v[124:127], v[40:43]
    ds_read_b128 v[88:91], v77 offset:1408
    buffer_load_dwordx4 v[172:175], v34, s[32:35], s82 offen offset:3072 sc1
    ds_read_b128 v[92:95], v77 offset:1472
    v_mfma_f32_16x16x32_bf16 v[40:43], v[104:107], v[128:131], v[40:43]
    ds_read_b64_tr_b16 a[198:199], v19 offset:21504
    v_mfma_f32_16x16x32_bf16 v[52:55], a[112:115], v[140:143], v[52:55]
    ds_read_b64_tr_b16 a[200:201], v25 offset:20480
    v_mfma_f32_16x16x32_bf16 v[56:59], a[116:119], v[140:143], v[56:59]
    s_waitcnt lgkmcnt(12)
    ds_read_b64_tr_b16 a[202:203], v25 offset:21504
    v_mfma_f32_16x16x32_bf16 v[60:63], a[120:123], v[140:143], v[60:63]
    ds_read_b64_tr_b16 a[204:205], v27 offset:20480
    v_mfma_f32_16x16x32_bf16 v[64:67], a[124:127], v[140:143], v[64:67]
    s_waitcnt vmcnt(7) lgkmcnt(11)
    ds_read_b64_tr_b16 a[206:207], v27 offset:21504
    v_mfma_f32_16x16x32_bf16 v[40:43], v[108:111], v[132:135], v[40:43]
    s_add_u32 m0, s66, 45056
    ds_read_b128 v[96:99], v77 offset:1536
    buffer_load_dwordx4 v46, s[16:19], s50 offen lds
    ds_read_b64_tr_b16 a[208:209], v16 offset:24576
    v_mfma_f32_16x16x32_bf16 v[52:55], a[128:131], v[144:147], v[52:55]
    ds_read_b64_tr_b16 a[210:211], v16 offset:25600
    v_mfma_f32_16x16x32_bf16 v[56:59], a[132:135], v[144:147], v[56:59]
    s_waitcnt lgkmcnt(12)
    ds_read_b64_tr_b16 a[212:213], v19 offset:24576
    v_mfma_f32_16x16x32_bf16 v[60:63], a[136:139], v[144:147], v[60:63]
    ds_read_b64_tr_b16 a[214:215], v19 offset:25600
    v_mfma_f32_16x16x32_bf16 v[64:67], a[140:143], v[144:147], v[64:67]
    s_waitcnt vmcnt(7) lgkmcnt(10)
    ds_read_b64_tr_b16 a[216:217], v25 offset:24576
    v_mfma_f32_16x16x32_bf16 v[40:43], v[88:91], v[136:139], v[40:43]
    s_add_u32 m0, s66, 49088
    ds_read_b128 v[100:103], v77 offset:1600
    buffer_load_dwordx4 v48, s[16:19], s50 offen offset:64 lds
    ds_read_b128 v[104:107], v77 offset:1664
    v_mfma_f32_16x16x32_bf16 v[40:43], v[92:95], v[140:143], v[40:43]
    ds_read_b64_tr_b16 a[218:219], v25 offset:25600
    v_mfma_f32_16x16x32_bf16 v[52:55], a[144:147], v[148:151], v[52:55]
    ds_read_b64_tr_b16 a[220:221], v27 offset:24576
    v_mfma_f32_16x16x32_bf16 v[56:59], a[148:151], v[148:151], v[56:59]
    s_waitcnt lgkmcnt(12)
    ds_read_b64_tr_b16 a[222:223], v27 offset:25600
    v_mfma_f32_16x16x32_bf16 v[60:63], a[152:155], v[148:151], v[60:63]
    ds_read_b64_tr_b16 a[224:225], v75 offset:4096
    v_mfma_f32_16x16x32_bf16 v[64:67], a[156:159], v[148:151], v[64:67]
    s_waitcnt vmcnt(7) lgkmcnt(11)
    ds_read_b64_tr_b16 a[226:227], v75 offset:5120
    v_mfma_f32_16x16x32_bf16 v[40:43], v[96:99], v[144:147], v[40:43]
    s_add_u32 m0, s66, 53120
    ds_read_b128 v[108:111], v77 offset:1728
    buffer_load_dwordx4 v48, s[16:19], s50 offen offset:128 lds
    ds_read_b64_tr_b16 a[228:229], v13 offset:4096
    v_mfma_f32_16x16x32_bf16 v[52:55], a[160:163], v[152:155], v[52:55]
    ds_read_b64_tr_b16 a[230:231], v13 offset:5120
    v_mfma_f32_16x16x32_bf16 v[56:59], a[164:167], v[152:155], v[56:59]
    s_waitcnt lgkmcnt(12)
    ds_read_b64_tr_b16 a[232:233], v14 offset:4096
    v_mfma_f32_16x16x32_bf16 v[60:63], a[168:171], v[152:155], v[60:63]
    ds_read_b64_tr_b16 a[234:235], v14 offset:5120
    v_mfma_f32_16x16x32_bf16 v[64:67], a[172:175], v[152:155], v[64:67]
    s_waitcnt vmcnt(7) lgkmcnt(10)
    ds_read_b64_tr_b16 a[236:237], v15 offset:4096
    v_mfma_f32_16x16x32_bf16 v[40:43], v[100:103], v[148:151], v[40:43]
    s_add_u32 m0, s66, 24576
    ds_read_b128 v[88:91], v77 offset:1792
    buffer_load_dwordx4 v47, s[16:19], s50 offen lds
    ds_read_b128 v[92:95], v77 offset:1856
    v_mfma_f32_16x16x32_bf16 v[40:43], v[104:107], v[152:155], v[40:43]
    ds_read_b64_tr_b16 a[238:239], v15 offset:5120
    v_mfma_f32_16x16x32_bf16 v[52:55], a[176:179], v[156:159], v[52:55]
    ds_read_b64_tr_b16 a[240:241], v75 offset:8192
    v_mfma_f32_16x16x32_bf16 v[56:59], a[180:183], v[156:159], v[56:59]
    s_waitcnt lgkmcnt(12)
    ds_read_b64_tr_b16 a[242:243], v75 offset:9216
    v_mfma_f32_16x16x32_bf16 v[60:63], a[184:187], v[156:159], v[60:63]
    ds_read_b64_tr_b16 a[244:245], v13 offset:8192
    v_mfma_f32_16x16x32_bf16 v[64:67], a[188:191], v[156:159], v[64:67]
    s_waitcnt vmcnt(7) lgkmcnt(11)
    ds_read_b64_tr_b16 a[246:247], v13 offset:9216
    v_mfma_f32_16x16x32_bf16 v[40:43], v[108:111], v[156:159], v[40:43]
    s_add_u32 m0, s66, 28608
    ds_read_b128 v[96:99], v77 offset:1920
    buffer_load_dwordx4 v49, s[16:19], s50 offen offset:64 lds
    v_mfma_f32_16x16x32_bf16 v[52:55], a[192:195], v[160:163], v[52:55]
    ds_read_b64_tr_b16 a[248:249], v14 offset:8192
    v_mfma_f32_16x16x32_bf16 v[56:59], a[196:199], v[160:163], v[56:59]
    ds_read_b64_tr_b16 a[250:251], v14 offset:9216
    v_mfma_f32_16x16x32_bf16 v[60:63], a[200:203], v[160:163], v[60:63]
    s_waitcnt lgkmcnt(12)
    ds_read_b64_tr_b16 a[252:253], v15 offset:8192
    v_mfma_f32_16x16x32_bf16 v[64:67], a[204:207], v[160:163], v[64:67]
    s_waitcnt vmcnt(7) lgkmcnt(9)
    ds_read_b64_tr_b16 a[254:255], v15 offset:9216
    v_mfma_f32_16x16x32_bf16 v[40:43], v[88:91], v[160:163], v[40:43]
    s_add_u32 m0, s66, 32640
    ds_read_b128 v[100:103], v77 offset:1984
    buffer_load_dwordx4 v49, s[16:19], s50 offen offset:128 lds
    v_mfma_f32_16x16x32_bf16 v[40:43], v[92:95], v[164:167], v[40:43]
    v_mfma_f32_16x16x32_bf16 v[52:55], a[208:211], v[164:167], v[52:55]
    v_mfma_f32_16x16x32_bf16 v[56:59], a[212:215], v[164:167], v[56:59]
    v_mfma_f32_16x16x32_bf16 v[60:63], a[216:219], v[164:167], v[60:63]
    v_mfma_f32_16x16x32_bf16 v[64:67], a[220:223], v[164:167], v[64:67]
    s_waitcnt vmcnt(7) lgkmcnt(5)
    v_mfma_f32_16x16x32_bf16 v[40:43], v[96:99], v[168:171], v[40:43]
    s_add_u32 m0, s66, 36864
    s_nop 0
    buffer_load_dwordx4 v46, s[16:19], s51 offen lds
    v_mfma_f32_16x16x32_bf16 v[52:55], a[224:227], v[168:171], v[52:55]
    v_mfma_f32_16x16x32_bf16 v[56:59], a[228:231], v[168:171], v[56:59]
    v_mfma_f32_16x16x32_bf16 v[60:63], a[232:235], v[168:171], v[60:63]
    v_mfma_f32_16x16x32_bf16 v[64:67], a[236:239], v[168:171], v[64:67]
    s_waitcnt vmcnt(7) lgkmcnt(0)
    v_mfma_f32_16x16x32_bf16 v[40:43], v[100:103], v[172:175], v[40:43]
    s_add_u32 m0, s66, 40896
    s_nop 0
    buffer_load_dwordx4 v48, s[16:19], s51 offen offset:64 lds
    v_mfma_f32_16x16x32_bf16 v[52:55], a[240:243], v[172:175], v[52:55]
    v_mfma_f32_16x16x32_bf16 v[56:59], a[244:247], v[172:175], v[56:59]
    v_mfma_f32_16x16x32_bf16 v[60:63], a[248:251], v[172:175], v[60:63]
    v_mfma_f32_16x16x32_bf16 v[64:67], a[252:255], v[172:175], v[64:67]
    s_add_u32 m0, s66, 57216
    s_nop 0
    buffer_load_dwordx4 v48, s[16:19], s51 offen offset:128 lds
    v_add_f32 v40, v40, v41
    v_sub_f32 v40, v7, v40
    v_pk_add_f32 v[176:177], v[52:53], v[40:41] op_sel_hi:[1,0]
    v_pk_add_f32 v[178:179], v[54:55], v[40:41] op_sel_hi:[1,0]
    v_cvt_pk_bf16_f32 v192, v176, v177
    v_cvt_pk_bf16_f32 v193, v178, v179
    v_pk_add_f32 v[180:181], v[56:57], v[40:41] op_sel_hi:[1,0]
    v_pk_add_f32 v[182:183], v[58:59], v[40:41] op_sel_hi:[1,0]
    v_cvt_pk_bf16_f32 v194, v180, v181
    v_cvt_pk_bf16_f32 v195, v182, v183
    buffer_store_dwordx4 v[192:195], v17, s[32:35], s87 offen offset:0
    v_pk_add_f32 v[184:185], v[60:61], v[40:41] op_sel_hi:[1,0]
    v_pk_add_f32 v[186:187], v[62:63], v[40:41] op_sel_hi:[1,0]
    v_cvt_pk_bf16_f32 v196, v184, v185
    v_cvt_pk_bf16_f32 v197, v186, v187
    v_pk_add_f32 v[188:189], v[64:65], v[40:41] op_sel_hi:[1,0]
    v_pk_add_f32 v[190:191], v[66:67], v[40:41] op_sel_hi:[1,0]
    v_cvt_pk_bf16_f32 v198, v188, v189
    v_cvt_pk_bf16_f32 v199, v190, v191
    buffer_store_dwordx4 v[196:199], v17, s[32:35], s87 offen offset:1024
    v_pk_mul_f32 v[38:39], v[176:177], v[176:177]
    v_pk_fma_f32 v[38:39], v[178:179], v[178:179], v[38:39]
    v_pk_fma_f32 v[38:39], v[180:181], v[180:181], v[38:39]
    v_pk_fma_f32 v[38:39], v[182:183], v[182:183], v[38:39]
    v_pk_fma_f32 v[38:39], v[184:185], v[184:185], v[38:39]
    v_pk_fma_f32 v[38:39], v[186:187], v[186:187], v[38:39]
    v_pk_fma_f32 v[38:39], v[188:189], v[188:189], v[38:39]
    v_pk_fma_f32 v[38:39], v[190:191], v[190:191], v[38:39]
    v_add_f32 v1, v38, v39
    v_add_f32 v38, v38, v39
    s_nop 1
    v_permlane16_swap_b32 v38, v1
    v_add_f32 v39, v38, v1
    v_add_f32 v38, v38, v1
    s_nop 1
    v_permlane32_swap_b32 v38, v39
    v_add_f32_e64 v38, v38, v39
    s_mov_b64 exec, 0xffff
    buffer_store_dword v38, v3, s[32:35], s88 offen
    s_mov_b64 exec, -1
    s_barrier
    s_add_u32 m0, s66, 61440
    s_nop 0
    buffer_load_dwordx4 v47, s[16:19], s51 offen lds
    s_add_u32 m0, s66, 65472
    s_nop 0
    buffer_load_dwordx4 v49, s[16:19], s51 offen offset:64 lds
    s_add_u32 m0, s66, 130944
    s_nop 0
    buffer_load_dwordx4 v49, s[16:19], s51 offen offset:128 lds
    s_lshl_b32 s73, s3, 15
    s_add_u32 s73, s73, s72
    s_lshl_b32 s91, s90, 10
    s_add_u32 s91, s91, s73
    s_add_u32 s73, s73, 131072
    v_add_u32 v7, s73, v17
    s_lshl2_add_u32 s73, s70, s3
    s_mul_i32 s74, s73, 6
    v_add_u32 v1, s74, v0
    v_and_b32 v2, 7, v1
    v_lshrrev_b32 v1, 3, v1
    v_lshlrev_b32 v2, 7, v2
    v_lshl_add_u32 v1, v1, 15, v2
    s_and_b32 s73, s73, 7
    s_mul_i32 s73, s73, 196608
    s_add_u32 s73, s73, 4294705536
    v_lshl_add_u32 v2, v0, 15, s73
    s_mov_b64 vcc, 0x3f00
    v_cndmask_b32 v1, v1, v2, vcc
    v_mov_b32 v2, 2146435072
    s_mov_b64 vcc, 0x3f00
    v_cndmask_b32 v1, v2, v1, vcc
    s_cmp_eq_u32 s90, 15
    s_cselect_b64 vcc, -1, 0
    s_cselect_b64 s[4:5], s[20:21], s[32:33]
    s_cselect_b32 s6, s22, s34
    v_cndmask_b32 v7, v7, v1, vcc
    v_add_u32 v35, 16384, v7
    s_add_u32 s73, s66, s72
    s_add_u32 s73, s73, 655360
    v_add_u32 v36, s73, v3
    s_and_b32 s92, s2, 7
    s_lshl_b32 s92, s92, 11
    s_waitcnt vmcnt(3)
    s_cmp_lg_u32 s60, 0
    s_cbranch_scc1 L_slowsig_9
    s_mov_b64 exec, 2
    buffer_store_dword v74, v69, s[32:35], 0 offen
    s_mov_b64 exec, -1
L_sigback_10:
    s_waitcnt lgkmcnt(0)
    s_barrier
    s_add_u32 m0, s66, 135168
    s_nop 0
    buffer_load_dwordx4 v46, s[16:19], s52 offen lds
    s_add_u32 m0, s66, 139200
    s_nop 0
    buffer_load_dwordx4 v48, s[16:19], s52 offen offset:64 lds
    s_add_u32 m0, s66, 143232
    s_nop 0
    buffer_load_dwordx4 v48, s[16:19], s52 offen offset:128 lds
    buffer_load_dword v10, v72, s[32:35], 0 offen offset:512 sc1
    s_add_u32 m0, s66, 147456
    s_nop 0
    buffer_load_dwordx4 v47, s[16:19], s52 offen lds
    s_add_u32 m0, s66, 151488
    s_nop 0
    buffer_load_dwordx4 v49, s[16:19], s52 offen offset:64 lds
    s_add_u32 m0, s66, 155520
    s_nop 0
    s_nop 0
    buffer_load_dwordx4 v49, s[16:19], s52 offen offset:128 lds
    ds_read_b64_tr_b16 v[40:41], v76 offset:12288
    ds_read_b64_tr_b16 v[42:43], v76 offset:14336
    ds_read_b64_tr_b16 v[176:177], v8 offset:12288
    ds_read_b64_tr_b16 v[178:179], v8 offset:14336
    ds_read_b64_tr_b16 v[180:181], v76 offset:13312
    ds_read_b64_tr_b16 v[182:183], v76 offset:15360
    ds_read_b64_tr_b16 v[184:185], v8 offset:13312
    ds_read_b64_tr_b16 v[186:187], v8 offset:15360
    ds_read_b64_tr_b16 v[188:189], v76 offset:16384
    ds_read_b64_tr_b16 v[190:191], v76 offset:18432
    ds_read_b64_tr_b16 v[192:193], v8 offset:16384
    ds_read_b64_tr_b16 v[194:195], v8 offset:18432
    s_lshl_b32 s73, s80, 11
    v_lshlrev_b32 v1, 10, v32
    v_subrev_u32 v1, s73, v1
    v_sub_u32 v75, v75, v1
    v_sub_u32 v16, v16, v1
    v_sub_u32 v18, v18, v1
    v_sub_u32 v13, v13, v1
    v_sub_u32 v19, v19, v1
    v_sub_u32 v24, v24, v1
    v_sub_u32 v14, v14, v1
    v_sub_u32 v25, v25, v1
    v_sub_u32 v26, v26, v1
    v_sub_u32 v15, v15, v1
    v_sub_u32 v27, v27, v1
    v_sub_u32 v28, v28, v1
    s_lshl_b32 s73, s80, 10
    v_add_u32 v34, s73, v34
    s_lshl_b32 s73, s80, 15
    s_sub_u32 s73, 16384, s73
    v_add_u32 v38, s73, v34
    s_mul_i32 s73, s80, 2146435072
    v_add_u32 v39, s73, v34
    v_add_u32 v50, s73, v38
    buffer_load_dword v11, v72, s[32:35], 0 offen offset:512 sc1
    s_branch L_poll_11_o
L_poll_11:
    s_mov_b32 s79, 0
    s_cmp_lg_u32 s60, 0
    s_cbranch_scc1 L_poll_11_s
    s_waitcnt vmcnt(0)
    v_cmp_ne_u32 vcc, s78, v11
    s_nop 0
    s_cbranch_vccz L_pollback_12
L_poll_11_l:
    buffer_load_dword v10, v72, s[32:35], 0 offen offset:512 sc1
    s_add_u32 s79, s79, 1
    s_waitcnt vmcnt(0)
    v_cmp_ne_u32 vcc, s78, v10
    s_nop 0
    s_cbranch_vccz L_pollback_12
    s_cmp_lt_u32 s79, 200
    s_cbranch_scc1 L_poll_11_l
    s_branch L_poll_11_t
L_poll_11_o:
    s_waitcnt vmcnt(4)
    v_cmp_ne_u32 vcc, s78, v10
    s_nop 0
    s_or_b64 s[56:57], vcc, s[60:61]
    s_nop 0
    s_cbranch_scc1 L_poll_11
L_pollback_12:
    buffer_load_dwordx4 a[0:3], v7, s[4:7], s92 offen offset:0 sc1
    buffer_load_dwordx4 a[4:7], v35, s[4:7], s92 offen offset:0 sc1
    buffer_load_dwordx4 a[8:11], v7, s[4:7], s92 offen offset:1024 sc1
    buffer_load_dwordx4 a[12:15], v35, s[4:7], s92 offen offset:1024 sc1
    s_add_u32 s92, s92, 2048
    s_and_b32 s92, s92, 0x3fff
    buffer_load_dwordx4 a[16:19], v7, s[4:7], s92 offen offset:0 sc1
    buffer_load_dwordx4 a[20:23], v35, s[4:7], s92 offen offset:0 sc1
    s_waitcnt vmcnt(4) lgkmcnt(8)
    v_mfma_f32_16x16x32_bf16 v[80:83], v[40:43], a[0:3], 0
    ds_read_b64_tr_b16 v[196:197], v76 offset:17408
    buffer_load_dwordx4 a[24:27], v7, s[4:7], s92 offen offset:1024 sc1
    v_mfma_f32_16x16x32_bf16 v[88:91], v[40:43], a[4:7], 0
    ds_read_b64_tr_b16 v[198:199], v76 offset:19456
    buffer_load_dwordx4 a[28:31], v35, s[4:7], s92 offen offset:1024 sc1
    v_mfma_f32_16x16x32_bf16 v[92:95], v[176:179], a[4:7], 0
    s_add_u32 s92, s92, 2048
    s_and_b32 s92, s92, 0x3fff
    ds_read_b64_tr_b16 v[200:201], v8 offset:17408
    v_mfma_f32_16x16x32_bf16 v[84:87], v[176:179], a[0:3], 0
    s_waitcnt lgkmcnt(7)
    ds_read_b64_tr_b16 v[202:203], v8 offset:19456
    v_mfma_f32_16x16x32_bf16 v[96:99], v[180:183], a[0:3], 0
    ds_read_b64_tr_b16 v[40:41], v76 offset:20480
    v_mfma_f32_16x16x32_bf16 v[104:107], v[180:183], a[4:7], 0
    ds_read_b64_tr_b16 v[42:43], v76 offset:22528
    buffer_load_dwordx4 a[32:35], v7, s[4:7], s92 offen offset:0 sc1
    v_mfma_f32_16x16x32_bf16 v[108:111], v[184:187], a[4:7], 0
    ds_read_b64_tr_b16 v[176:177], v8 offset:20480
    v_mfma_f32_16x16x32_bf16 v[100:103], v[184:187], a[0:3], 0
    s_waitcnt lgkmcnt(7)
    ds_read_b64_tr_b16 v[178:179], v8 offset:22528
    v_mfma_f32_16x16x32_bf16 v[112:115], v[188:191], a[0:3], 0
    ds_read_b64_tr_b16 v[180:181], v76 offset:21504
    v_mfma_f32_16x16x32_bf16 v[120:123], v[188:191], a[4:7], 0
    ds_read_b64_tr_b16 v[182:183], v76 offset:23552
    buffer_load_dwordx4 a[36:39], v35, s[4:7], s92 offen offset:0 sc1
    v_mfma_f32_16x16x32_bf16 v[124:127], v[192:195], a[4:7], 0
    ds_read_b64_tr_b16 v[184:185], v8 offset:21504
    v_mfma_f32_16x16x32_bf16 v[116:119], v[192:195], a[0:3], 0
    s_waitcnt lgkmcnt(7)
    ds_read_b64_tr_b16 v[186:187], v8 offset:23552
    v_mfma_f32_16x16x32_bf16 v[128:131], v[196:199], a[0:3], 0
    ds_read_b64_tr_b16 v[188:189], v9 offset:28672
    v_mfma_f32_16x16x32_bf16 v[136:139], v[196:199], a[4:7], 0
    ds_read_b64_tr_b16 v[190:191], v9 offset:30720
    buffer_load_dwordx4 a[40:43], v7, s[4:7], s92 offen offset:1024 sc1
    v_mfma_f32_16x16x32_bf16 v[140:143], v[200:203], a[4:7], 0
    ds_read_b64_tr_b16 v[192:193], v30 offset:28672
    v_mfma_f32_16x16x32_bf16 v[132:135], v[200:203], a[0:3], 0
    s_waitcnt lgkmcnt(7)
    ds_read_b64_tr_b16 v[194:195], v30 offset:30720
    v_mfma_f32_16x16x32_bf16 v[144:147], v[40:43], a[0:3], 0
    ds_read_b64_tr_b16 v[196:197], v9 offset:29696
    v_mfma_f32_16x16x32_bf16 v[152:155], v[40:43], a[4:7], 0
    ds_read_b64_tr_b16 v[198:199], v9 offset:31744
    buffer_load_dwordx4 a[44:47], v35, s[4:7], s92 offen offset:1024 sc1
    v_mfma_f32_16x16x32_bf16 v[156:159], v[176:179], a[4:7], 0
    s_add_u32 s92, s92, 2048
    s_and_b32 s92, s92, 0x3fff
    ds_read_b64_tr_b16 v[200:201], v30 offset:29696
    v_mfma_f32_16x16x32_bf16 v[148:151], v[176:179], a[0:3], 0
    s_waitcnt lgkmcnt(7)
    ds_read_b64_tr_b16 v[202:203], v30 offset:31744
    v_mfma_f32_16x16x32_bf16 v[160:163], v[180:183], a[0:3], 0
    ds_read_b64_tr_b16 v[40:41], v9 offset:32768
    v_mfma_f32_16x16x32_bf16 v[168:171], v[180:183], a[4:7], 0
    ds_read_b64_tr_b16 v[42:43], v9 offset:34816
    buffer_load_dwordx4 a[48:51], v7, s[4:7], s92 offen offset:0 sc1
    v_mfma_f32_16x16x32_bf16 v[172:175], v[184:187], a[4:7], 0
    ds_read_b64_tr_b16 v[176:177], v30 offset:32768
    v_mfma_f32_16x16x32_bf16 v[164:167], v[184:187], a[0:3], 0
    s_waitcnt vmcnt(9) lgkmcnt(7)
    ds_read_b64_tr_b16 v[178:179], v30 offset:34816
    v_mfma_f32_16x16x32_bf16 v[80:83], v[188:191], a[8:11], v[80:83]
    ds_read_b64_tr_b16 v[180:181], v9 offset:33792
    v_mfma_f32_16x16x32_bf16 v[88:91], v[188:191], a[12:15], v[88:91]
    ds_read_b64_tr_b16 v[182:183], v9 offset:35840
    buffer_load_dwordx4 a[52:55], v35, s[4:7], s92 offen offset:0 sc1
    v_mfma_f32_16x16x32_bf16 v[92:95], v[192:195], a[12:15], v[92:95]
    ds_read_b64_tr_b16 v[184:185], v30 offset:33792
    v_mfma_f32_16x16x32_bf16 v[84:87], v[192:195], a[8:11], v[84:87]
    s_waitcnt lgkmcnt(7)
    ds_read_b64_tr_b16 v[186:187], v30 offset:35840
    v_mfma_f32_16x16x32_bf16 v[96:99], v[196:199], a[8:11], v[96:99]
    ds_read_b64_tr_b16 v[188:189], v9 offset:36864
    v_mfma_f32_16x16x32_bf16 v[104:107], v[196:199], a[12:15], v[104:107]
    ds_read_b64_tr_b16 v[190:191], v9 offset:38912
    buffer_load_dwordx4 a[56:59], v7, s[4:7], s92 offen offset:1024 sc1
    v_mfma_f32_16x16x32_bf16 v[108:111], v[200:203], a[12:15], v[108:111]
    ds_read_b64_tr_b16 v[192:193], v30 offset:36864
    v_mfma_f32_16x16x32_bf16 v[100:103], v[200:203], a[8:11], v[100:103]
    s_waitcnt lgkmcnt(7)
    ds_read_b64_tr_b16 v[194:195], v30 offset:38912
    v_mfma_f32_16x16x32_bf16 v[112:115], v[40:43], a[8:11], v[112:115]
    ds_read_b64_tr_b16 v[196:197], v9 offset:37888
    v_mfma_f32_16x16x32_bf16 v[120:123], v[40:43], a[12:15], v[120:123]
    ds_read_b64_tr_b16 v[198:199], v9 offset:39936
    buffer_load_dwordx4 a[60:63], v35, s[4:7], s92 offen offset:1024 sc1
    v_mfma_f32_16x16x32_bf16 v[124:127], v[176:179], a[12:15], v[124:127]
    s_add_u32 s92, s92, 2048
    s_and_b32 s92, s92, 0x3fff
    ds_read_b64_tr_b16 v[200:201], v30 offset:37888
    v_mfma_f32_16x16x32_bf16 v[116:119], v[176:179], a[8:11], v[116:119]
    s_waitcnt lgkmcnt(7)
    ds_read_b64_tr_b16 v[202:203], v30 offset:39936
    v_mfma_f32_16x16x32_bf16 v[128:131], v[180:183], a[8:11], v[128:131]
    ds_read_b64_tr_b16 v[40:41], v9 offset:40960
    v_mfma_f32_16x16x32_bf16 v[136:139], v[180:183], a[12:15], v[136:139]
    ds_read_b64_tr_b16 v[42:43], v9 offset:43008
    buffer_load_dwordx2 v[220:221], v36, s[32:35], 0 offen offset:0 sc1
    v_mfma_f32_16x16x32_bf16 v[140:143], v[184:187], a[12:15], v[140:143]
    ds_read_b64_tr_b16 v[176:177], v30 offset:40960
    v_mfma_f32_16x16x32_bf16 v[132:135], v[184:187], a[8:11], v[132:135]
    s_waitcnt lgkmcnt(7)
    ds_read_b64_tr_b16 v[178:179], v30 offset:43008
    v_mfma_f32_16x16x32_bf16 v[144:147], v[188:191], a[8:11], v[144:147]
    ds_read_b64_tr_b16 v[180:181], v9 offset:41984
    v_mfma_f32_16x16x32_bf16 v[152:155], v[188:191], a[12:15], v[152:155]
    ds_read_b64_tr_b16 v[182:183], v9 offset:44032
    buffer_load_dwordx2 v[222:223], v36, s[32:35], 0 offen offset:512 sc1
    v_mfma_f32_16x16x32_bf16 v[156:159], v[192:195], a[12:15], v[156:159]
    ds_read_b64_tr_b16 v[184:185], v30 offset:41984
    v_mfma_f32_16x16x32_bf16 v[148:151], v[192:195], a[8:11], v[148:151]
    s_waitcnt lgkmcnt(7)
    ds_read_b64_tr_b16 v[186:187], v30 offset:44032
    v_mfma_f32_16x16x32_bf16 v[160:163], v[196:199], a[8:11], v[160:163]
    ds_read_b64_tr_b16 v[188:189], v9 offset:45056
    v_mfma_f32_16x16x32_bf16 v[168:171], v[196:199], a[12:15], v[168:171]
    ds_read_b64_tr_b16 v[190:191], v9 offset:47104
    buffer_load_dwordx4 a[64:67], v7, s[4:7], s92 offen offset:0 sc1
    v_mfma_f32_16x16x32_bf16 v[172:175], v[200:203], a[12:15], v[172:175]
    ds_read_b64_tr_b16 v[192:193], v30 offset:45056
    v_mfma_f32_16x16x32_bf16 v[164:167], v[200:203], a[8:11], v[164:167]
    s_waitcnt vmcnt(13) lgkmcnt(7)
    ds_read_b64_tr_b16 v[194:195], v30 offset:47104
    v_mfma_f32_16x16x32_bf16 v[80:83], v[40:43], a[16:19], v[80:83]
    ds_read_b64_tr_b16 v[196:197], v9 offset:46080
    v_mfma_f32_16x16x32_bf16 v[88:91], v[40:43], a[20:23], v[88:91]
    ds_read_b64_tr_b16 v[198:199], v9 offset:48128
    buffer_load_dwordx4 a[68:71], v35, s[4:7], s92 offen offset:0 sc1
    v_mfma_f32_16x16x32_bf16 v[92:95], v[176:179], a[20:23], v[92:95]
    ds_read_b64_tr_b16 v[200:201], v30 offset:46080
    v_mfma_f32_16x16x32_bf16 v[84:87], v[176:179], a[16:19], v[84:87]
L_warm_3:
    s_cbranch_execz L_warm_back
    s_waitcnt lgkmcnt(7)
    ds_read_b64_tr_b16 v[202:203], v30 offset:48128
    v_mfma_f32_16x16x32_bf16 v[96:99], v[180:183], a[16:19], v[96:99]
    ds_read_b64_tr_b16 v[40:41], v9 offset:49152
    v_mfma_f32_16x16x32_bf16 v[104:107], v[180:183], a[20:23], v[104:107]
    s_add_u32 m0, s66, 159744
    ds_read_b64_tr_b16 v[42:43], v9 offset:51200
    buffer_load_dwordx4 v46, s[16:19], s53 offen lds
    v_mfma_f32_16x16x32_bf16 v[108:111], v[184:187], a[20:23], v[108:111]
    ds_read_b64_tr_b16 v[176:177], v30 offset:49152
    v_mfma_f32_16x16x32_bf16 v[100:103], v[184:187], a[16:19], v[100:103]
    s_waitcnt lgkmcnt(7)
    ds_read_b64_tr_b16 v[178:179], v30 offset:51200
    v_mfma_f32_16x16x32_bf16 v[112:115], v[188:191], a[16:19], v[112:115]
    ds_read_b64_tr_b16 v[180:181], v9 offset:50176
    v_mfma_f32_16x16x32_bf16 v[120:123], v[188:191], a[20:23], v[120:123]
    s_add_u32 m0, s66, 69568
    ds_read_b64_tr_b16 v[182:183], v9 offset:52224
    buffer_load_dwordx4 v48, s[16:19], s53 offen offset:64 lds
    v_mfma_f32_16x16x32_bf16 v[124:127], v[192:195], a[20:23], v[124:127]
    ds_read_b64_tr_b16 v[184:185], v30 offset:50176
    v_mfma_f32_16x16x32_bf16 v[116:119], v[192:195], a[16:19], v[116:119]
    s_waitcnt lgkmcnt(7)
    ds_read_b64_tr_b16 v[186:187], v30 offset:52224
    v_mfma_f32_16x16x32_bf16 v[128:131], v[196:199], a[16:19], v[128:131]
    ds_read_b64_tr_b16 v[188:189], v9 offset:53248
    v_mfma_f32_16x16x32_bf16 v[136:139], v[196:199], a[20:23], v[136:139]
    s_add_u32 m0, s66, 73600
    ds_read_b64_tr_b16 v[190:191], v9 offset:55296
    buffer_load_dwordx4 v48, s[16:19], s53 offen offset:128 lds
    v_mfma_f32_16x16x32_bf16 v[140:143], v[200:203], a[20:23], v[140:143]
    ds_read_b64_tr_b16 v[192:193], v30 offset:53248
    v_mfma_f32_16x16x32_bf16 v[132:135], v[200:203], a[16:19], v[132:135]
    s_waitcnt lgkmcnt(7)
    ds_read_b64_tr_b16 v[194:195], v30 offset:55296
    v_mfma_f32_16x16x32_bf16 v[144:147], v[40:43], a[16:19], v[144:147]
    ds_read_b64_tr_b16 v[196:197], v9 offset:54272
    v_mfma_f32_16x16x32_bf16 v[152:155], v[40:43], a[20:23], v[152:155]
    s_add_u32 m0, s66, 77824
    ds_read_b64_tr_b16 v[198:199], v9 offset:56320
    buffer_load_dwordx4 v47, s[16:19], s53 offen lds
    v_mfma_f32_16x16x32_bf16 v[156:159], v[176:179], a[20:23], v[156:159]
    ds_read_b64_tr_b16 v[200:201], v30 offset:54272
    v_mfma_f32_16x16x32_bf16 v[148:151], v[176:179], a[16:19], v[148:151]
    s_waitcnt lgkmcnt(7)
    ds_read_b64_tr_b16 v[202:203], v30 offset:56320
    v_mfma_f32_16x16x32_bf16 v[160:163], v[180:183], a[16:19], v[160:163]
    ds_read_b64_tr_b16 v[40:41], v9 offset:57344
    v_mfma_f32_16x16x32_bf16 v[168:171], v[180:183], a[20:23], v[168:171]
    s_add_u32 m0, s66, 81856
    ds_read_b64_tr_b16 v[42:43], v9 offset:59392
    buffer_load_dwordx4 v49, s[16:19], s53 offen offset:64 lds
    v_mfma_f32_16x16x32_bf16 v[172:175], v[184:187], a[20:23], v[172:175]
    ds_read_b64_tr_b16 v[176:177], v30 offset:57344
    v_mfma_f32_16x16x32_bf16 v[164:167], v[184:187], a[16:19], v[164:167]
    s_waitcnt vmcnt(17) lgkmcnt(7)
    ds_read_b64_tr_b16 v[178:179], v30 offset:59392
    v_mfma_f32_16x16x32_bf16 v[80:83], v[188:191], a[24:27], v[80:83]
    ds_read_b64_tr_b16 v[180:181], v9 offset:58368
    v_mfma_f32_16x16x32_bf16 v[88:91], v[188:191], a[28:31], v[88:91]
    s_add_u32 m0, s66, 85888
    ds_read_b64_tr_b16 v[182:183], v9 offset:60416
    buffer_load_dwordx4 v49, s[16:19], s53 offen offset:128 lds
    v_mfma_f32_16x16x32_bf16 v[92:95], v[192:195], a[28:31], v[92:95]
    ds_read_b64_tr_b16 v[184:185], v30 offset:58368
    v_mfma_f32_16x16x32_bf16 v[84:87], v[192:195], a[24:27], v[84:87]
    s_waitcnt lgkmcnt(7)
    ds_read_b64_tr_b16 v[186:187], v30 offset:60416
    v_mfma_f32_16x16x32_bf16 v[96:99], v[196:199], a[24:27], v[96:99]
    ds_read_b64_tr_b16 v[188:189], v9 offset:61440
    v_mfma_f32_16x16x32_bf16 v[104:107], v[196:199], a[28:31], v[104:107]
    ds_read_b64_tr_b16 v[190:191], v9 offset:63488
    buffer_load_dwordx4 a[72:75], v7, s[4:7], s92 offen offset:1024 sc1
    v_mfma_f32_16x16x32_bf16 v[108:111], v[200:203], a[28:31], v[108:111]
    ds_read_b64_tr_b16 v[192:193], v30 offset:61440
    v_mfma_f32_16x16x32_bf16 v[100:103], v[200:203], a[24:27], v[100:103]
    s_waitcnt lgkmcnt(7)
    ds_read_b64_tr_b16 v[194:195], v30 offset:63488
    v_mfma_f32_16x16x32_bf16 v[112:115], v[40:43], a[24:27], v[112:115]
    ds_read_b64_tr_b16 v[196:197], v9 offset:62464
    v_mfma_f32_16x16x32_bf16 v[120:123], v[40:43], a[28:31], v[120:123]
    ds_read_b64_tr_b16 v[198:199], v9 offset:64512
    buffer_load_dwordx4 a[76:79], v35, s[4:7], s92 offen offset:1024 sc1
    v_mfma_f32_16x16x32_bf16 v[124:127], v[176:179], a[28:31], v[124:127]
    s_add_u32 s92, s92, 2048
    s_and_b32 s92, s92, 0x3fff
    ds_read_b64_tr_b16 v[200:201], v30 offset:62464
    v_mfma_f32_16x16x32_bf16 v[116:119], v[176:179], a[24:27], v[116:119]
    s_waitcnt lgkmcnt(7)
    ds_read_b64_tr_b16 v[202:203], v30 offset:64512
    v_mfma_f32_16x16x32_bf16 v[128:131], v[180:183], a[24:27], v[128:131]
    ds_read_b64_tr_b16 v[40:41], v76 offset:45056
    v_mfma_f32_16x16x32_bf16 v[136:139], v[180:183], a[28:31], v[136:139]
    ds_read_b64_tr_b16 v[42:43], v76 offset:47104
    buffer_load_dwordx4 a[80:83], v7, s[4:7], s92 offen offset:0 sc1
    v_mfma_f32_16x16x32_bf16 v[140:143], v[184:187], a[28:31], v[140:143]
    ds_read_b64_tr_b16 v[176:177], v8 offset:45056
    v_mfma_f32_16x16x32_bf16 v[132:135], v[184:187], a[24:27], v[132:135]
    s_waitcnt lgkmcnt(7)
    ds_read_b64_tr_b16 v[178:179], v8 offset:47104
    v_mfma_f32_16x16x32_bf16 v[144:147], v[188:191], a[24:27], v[144:147]
    ds_read_b64_tr_b16 v[180:181], v76 offset:46080
    v_mfma_f32_16x16x32_bf16 v[152:155], v[188:191], a[28:31], v[152:155]
    ds_read_b64_tr_b16 v[182:183], v76 offset:48128
    buffer_load_dwordx4 a[84:87], v35, s[4:7], s92 offen offset:0 sc1
    v_mfma_f32_16x16x32_bf16 v[156:159], v[192:195], a[28:31], v[156:159]
    ds_read_b64_tr_b16 v[184:185], v8 offset:46080
    v_mfma_f32_16x16x32_bf16 v[148:151], v[192:195], a[24:27], v[148:151]
    s_waitcnt lgkmcnt(7)
    ds_read_b64_tr_b16 v[186:187], v8 offset:48128
    v_mfma_f32_16x16x32_bf16 v[160:163], v[196:199], a[24:27], v[160:163]
    ds_read_b64_tr_b16 v[188:189], v76 offset:49152
    v_mfma_f32_16x16x32_bf16 v[168:171], v[196:199], a[28:31], v[168:171]
    s_add_u32 m0, s66, 90112
    ds_read_b64_tr_b16 v[190:191], v76 offset:51200
    buffer_load_dwordx4 v46, s[16:19], s54 offen lds
    v_mfma_f32_16x16x32_bf16 v[172:175], v[200:203], a[28:31], v[172:175]
    ds_read_b64_tr_b16 v[192:193], v8 offset:49152
    v_mfma_f32_16x16x32_bf16 v[164:167], v[200:203], a[24:27], v[164:167]
    s_waitcnt vmcnt(21) lgkmcnt(7)
    ds_read_b64_tr_b16 v[194:195], v8 offset:51200
    s_waitcnt vmcnt(10)
    s_barrier
    v_mfma_f32_16x16x32_bf16 v[80:83], v[40:43], a[32:35], v[80:83]
    ds_read_b64_tr_b16 v[196:197], v76 offset:50176
    v_mfma_f32_16x16x32_bf16 v[88:91], v[40:43], a[36:39], v[88:91]
    s_add_u32 m0, s66, 4032
    ds_read_b64_tr_b16 v[198:199], v76 offset:52224
    buffer_load_dwordx4 v48, s[16:19], s54 offen offset:64 lds
    v_mfma_f32_16x16x32_bf16 v[92:95], v[176:179], a[36:39], v[92:95]
    ds_read_b64_tr_b16 v[200:201], v8 offset:50176
    v_mfma_f32_16x16x32_bf16 v[84:87], v[176:179], a[32:35], v[84:87]
    s_waitcnt lgkmcnt(7)
    ds_read_b64_tr_b16 v[202:203], v8 offset:52224
    v_mfma_f32_16x16x32_bf16 v[96:99], v[180:183], a[32:35], v[96:99]
    ds_read_b64_tr_b16 v[40:41], v76 offset:53248
    v_mfma_f32_16x16x32_bf16 v[104:107], v[180:183], a[36:39], v[104:107]
    s_add_u32 m0, s66, 8064
    ds_read_b64_tr_b16 v[42:43], v76 offset:55296
    buffer_load_dwordx4 v48, s[16:19], s54 offen offset:128 lds
    v_mfma_f32_16x16x32_bf16 v[108:111], v[184:187], a[36:39], v[108:111]
    ds_read_b64_tr_b16 v[176:177], v8 offset:53248
    v_mfma_f32_16x16x32_bf16 v[100:103], v[184:187], a[32:35], v[100:103]
    s_waitcnt lgkmcnt(7)
    ds_read_b64_tr_b16 v[178:179], v8 offset:55296
    v_mfma_f32_16x16x32_bf16 v[112:115], v[188:191], a[32:35], v[112:115]
    ds_read_b64_tr_b16 v[180:181], v76 offset:54272
    v_mfma_f32_16x16x32_bf16 v[120:123], v[188:191], a[36:39], v[120:123]
    s_add_u32 m0, s66, 12288
    ds_read_b64_tr_b16 v[182:183], v76 offset:56320
    buffer_load_dwordx4 v47, s[16:19], s54 offen lds
    v_mfma_f32_16x16x32_bf16 v[124:127], v[192:195], a[36:39], v[124:127]
    ds_read_b64_tr_b16 v[184:185], v8 offset:54272
    v_mfma_f32_16x16x32_bf16 v[116:119], v[192:195], a[32:35], v[116:119]
    s_waitcnt lgkmcnt(7)
    ds_read_b64_tr_b16 v[186:187], v8 offset:56320
    v_mfma_f32_16x16x32_bf16 v[128:131], v[196:199], a[32:35], v[128:131]
    ds_read_b64_tr_b16 v[188:189], v76 offset:24576
    v_mfma_f32_16x16x32_bf16 v[136:139], v[196:199], a[36:39], v[136:139]
    s_add_u32 m0, s66, 16320
    ds_read_b64_tr_b16 v[190:191], v76 offset:26624
    buffer_load_dwordx4 v49, s[16:19], s54 offen offset:64 lds
    v_mfma_f32_16x16x32_bf16 v[140:143], v[200:203], a[36:39], v[140:143]
    ds_read_b64_tr_b16 v[192:193], v8 offset:24576
    v_mfma_f32_16x16x32_bf16 v[132:135], v[200:203], a[32:35], v[132:135]
    s_waitcnt lgkmcnt(7)
    ds_read_b64_tr_b16 v[194:195], v8 offset:26624
    v_mfma_f32_16x16x32_bf16 v[144:147], v[40:43], a[32:35], v[144:147]
    ds_read_b64_tr_b16 v[196:197], v76 offset:25600
    v_mfma_f32_16x16x32_bf16 v[152:155], v[40:43], a[36:39], v[152:155]
    s_add_u32 m0, s66, 20352
    ds_read_b64_tr_b16 v[198:199], v76 offset:27648
    buffer_load_dwordx4 v49, s[16:19], s54 offen offset:128 lds
    v_mfma_f32_16x16x32_bf16 v[156:159], v[176:179], a[36:39], v[156:159]
    ds_read_b64_tr_b16 v[200:201], v8 offset:25600
    v_mfma_f32_16x16x32_bf16 v[148:151], v[176:179], a[32:35], v[148:151]
    s_waitcnt lgkmcnt(7)
    ds_read_b64_tr_b16 v[202:203], v8 offset:27648
    v_mfma_f32_16x16x32_bf16 v[160:163], v[180:183], a[32:35], v[160:163]
    ds_read_b64_tr_b16 v[40:41], v76 offset:28672
    v_mfma_f32_16x16x32_bf16 v[168:171], v[180:183], a[36:39], v[168:171]
    ds_read_b64_tr_b16 v[42:43], v76 offset:30720
    buffer_load_dwordx4 a[88:91], v7, s[4:7], s92 offen offset:1024 sc1
    v_mfma_f32_16x16x32_bf16 v[172:175], v[184:187], a[36:39], v[172:175]
    ds_read_b64_tr_b16 v[176:177], v8 offset:28672
    v_mfma_f32_16x16x32_bf16 v[164:167], v[184:187], a[32:35], v[164:167]
    s_waitcnt lgkmcnt(7)
    ds_read_b64_tr_b16 v[178:179], v8 offset:30720
    v_mfma_f32_16x16x32_bf16 v[80:83], v[188:191], a[40:43], v[80:83]
    ds_read_b64_tr_b16 v[180:181], v76 offset:29696
    v_mfma_f32_16x16x32_bf16 v[88:91], v[188:191], a[44:47], v[88:91]
    ds_read_b64_tr_b16 v[182:183], v76 offset:31744
    buffer_load_dwordx4 a[92:95], v35, s[4:7], s92 offen offset:1024 sc1
    v_mfma_f32_16x16x32_bf16 v[92:95], v[192:195], a[44:47], v[92:95]
    s_add_u32 s92, s92, 2048
    s_and_b32 s92, s92, 0x3fff
    ds_read_b64_tr_b16 v[184:185], v8 offset:29696
    v_mfma_f32_16x16x32_bf16 v[84:87], v[192:195], a[40:43], v[84:87]
    s_waitcnt lgkmcnt(7)
    ds_read_b64_tr_b16 v[186:187], v8 offset:31744
    v_mfma_f32_16x16x32_bf16 v[96:99], v[196:199], a[40:43], v[96:99]
    ds_read_b64_tr_b16 v[188:189], v76 offset:32768
    v_mfma_f32_16x16x32_bf16 v[104:107], v[196:199], a[44:47], v[104:107]
    ds_read_b64_tr_b16 v[190:191], v76 offset:34816
    buffer_load_dwordx4 a[96:99], v7, s[4:7], s92 offen offset:0 sc1
    v_mfma_f32_16x16x32_bf16 v[108:111], v[200:203], a[44:47], v[108:111]
    ds_read_b64_tr_b16 v[192:193], v8 offset:32768
    v_mfma_f32_16x16x32_bf16 v[100:103], v[200:203], a[40:43], v[100:103]
    s_waitcnt lgkmcnt(7)
    ds_read_b64_tr_b16 v[194:195], v8 offset:34816
    v_mfma_f32_16x16x32_bf16 v[112:115], v[40:43], a[40:43], v[112:115]
    ds_read_b64_tr_b16 v[196:197], v76 offset:33792
    v_mfma_f32_16x16x32_bf16 v[120:123], v[40:43], a[44:47], v[120:123]
    ds_read_b64_tr_b16 v[198:199], v76 offset:35840
    v_mfma_f32_16x16x32_bf16 v[124:127], v[176:179], a[44:47], v[124:127]
    ds_read_b64_tr_b16 v[200:201], v8 offset:33792
    v_mfma_f32_16x16x32_bf16 v[116:119], v[176:179], a[40:43], v[116:119]
    s_waitcnt lgkmcnt(7)
    ds_read_b64_tr_b16 v[202:203], v8 offset:35840
    v_mfma_f32_16x16x32_bf16 v[128:131], v[180:183], a[40:43], v[128:131]
    ds_read_b64_tr_b16 v[40:41], v76 offset:36864
    v_mfma_f32_16x16x32_bf16 v[136:139], v[180:183], a[44:47], v[136:139]
    ds_read_b64_tr_b16 v[42:43], v76 offset:38912
    buffer_load_dwordx4 a[100:103], v35, s[4:7], s92 offen offset:0 sc1
    v_mfma_f32_16x16x32_bf16 v[140:143], v[184:187], a[44:47], v[140:143]
    ds_read_b64_tr_b16 v[176:177], v8 offset:36864
    v_mfma_f32_16x16x32_bf16 v[132:135], v[184:187], a[40:43], v[132:135]
    s_waitcnt lgkmcnt(7)
    ds_read_b64_tr_b16 v[178:179], v8 offset:38912
    v_mfma_f32_16x16x32_bf16 v[144:147], v[188:191], a[40:43], v[144:147]
    ds_read_b64_tr_b16 v[180:181], v76 offset:37888
    v_mfma_f32_16x16x32_bf16 v[152:155], v[188:191], a[44:47], v[152:155]
    s_add_u32 m0, s66, 94208
    ds_read_b64_tr_b16 v[182:183], v76 offset:39936
    buffer_load_dwordx4 v46, s[16:19], s55 offen lds
    v_mfma_f32_16x16x32_bf16 v[156:159], v[192:195], a[44:47], v[156:159]
    ds_read_b64_tr_b16 v[184:185], v8 offset:37888
    v_mfma_f32_16x16x32_bf16 v[148:151], v[192:195], a[40:43], v[148:151]
    s_waitcnt lgkmcnt(7)
    ds_read_b64_tr_b16 v[186:187], v8 offset:39936
    v_mfma_f32_16x16x32_bf16 v[160:163], v[196:199], a[40:43], v[160:163]
    ds_read_b64_tr_b16 v[188:189], v76 offset:40960
    v_mfma_f32_16x16x32_bf16 v[168:171], v[196:199], a[44:47], v[168:171]
    s_add_u32 m0, s66, 98240
    ds_read_b64_tr_b16 v[190:191], v76 offset:43008
    buffer_load_dwordx4 v48, s[16:19], s55 offen offset:64 lds
    v_mfma_f32_16x16x32_bf16 v[172:175], v[200:203], a[44:47], v[172:175]
    ds_read_b64_tr_b16 v[192:193], v8 offset:40960
    v_mfma_f32_16x16x32_bf16 v[164:167], v[200:203], a[40:43], v[164:167]
    s_waitcnt lgkmcnt(7)
    ds_read_b64_tr_b16 v[194:195], v8 offset:43008
    s_waitcnt vmcnt(10)
    s_barrier
    v_mfma_f32_16x16x32_bf16 v[80:83], v[40:43], a[48:51], v[80:83]
    ds_read_b64_tr_b16 v[196:197], v76 offset:41984
    v_mfma_f32_16x16x32_bf16 v[88:91], v[40:43], a[52:55], v[88:91]
    ds_read_b64_tr_b16 v[198:199], v76 offset:44032
    v_mfma_f32_16x16x32_bf16 v[92:95], v[176:179], a[52:55], v[92:95]
    ds_read_b64_tr_b16 v[200:201], v8 offset:41984
    v_mfma_f32_16x16x32_bf16 v[84:87], v[176:179], a[48:51], v[84:87]
    s_waitcnt lgkmcnt(7)
    ds_read_b64_tr_b16 v[202:203], v8 offset:44032
    v_mfma_f32_16x16x32_bf16 v[96:99], v[180:183], a[48:51], v[96:99]
    ds_read_b64_tr_b16 v[40:41], v76 offset:57344
    v_mfma_f32_16x16x32_bf16 v[104:107], v[180:183], a[52:55], v[104:107]
    s_add_u32 m0, s66, 102272
    ds_read_b64_tr_b16 v[42:43], v76 offset:59392
    buffer_load_dwordx4 v48, s[16:19], s55 offen offset:128 lds
    v_mfma_f32_16x16x32_bf16 v[108:111], v[184:187], a[52:55], v[108:111]
    ds_read_b64_tr_b16 v[176:177], v8 offset:57344
    v_mfma_f32_16x16x32_bf16 v[100:103], v[184:187], a[48:51], v[100:103]
    s_waitcnt lgkmcnt(7)
    ds_read_b64_tr_b16 v[178:179], v8 offset:59392
    v_mfma_f32_16x16x32_bf16 v[112:115], v[188:191], a[48:51], v[112:115]
    ds_read_b64_tr_b16 v[180:181], v76 offset:58368
    v_mfma_f32_16x16x32_bf16 v[120:123], v[188:191], a[52:55], v[120:123]
    s_add_u32 m0, s66, 106496
    ds_read_b64_tr_b16 v[182:183], v76 offset:60416
    buffer_load_dwordx4 v47, s[16:19], s55 offen lds
    v_mfma_f32_16x16x32_bf16 v[124:127], v[192:195], a[52:55], v[124:127]
    ds_read_b64_tr_b16 v[184:185], v8 offset:58368
    v_mfma_f32_16x16x32_bf16 v[116:119], v[192:195], a[48:51], v[116:119]
    s_waitcnt lgkmcnt(7)
    ds_read_b64_tr_b16 v[186:187], v8 offset:60416
    v_mfma_f32_16x16x32_bf16 v[128:131], v[196:199], a[48:51], v[128:131]
    ds_read_b64_tr_b16 v[188:189], v76 offset:61440
    v_mfma_f32_16x16x32_bf16 v[136:139], v[196:199], a[52:55], v[136:139]
    s_add_u32 m0, s66, 110528
    ds_read_b64_tr_b16 v[190:191], v76 offset:63488
    buffer_load_dwordx4 v49, s[16:19], s55 offen offset:64 lds
    v_mfma_f32_16x16x32_bf16 v[140:143], v[200:203], a[52:55], v[140:143]
    ds_read_b64_tr_b16 v[192:193], v8 offset:61440
    v_mfma_f32_16x16x32_bf16 v[132:135], v[200:203], a[48:51], v[132:135]
    s_waitcnt lgkmcnt(7)
    ds_read_b64_tr_b16 v[194:195], v8 offset:63488
    v_mfma_f32_16x16x32_bf16 v[144:147], v[40:43], a[48:51], v[144:147]
    ds_read_b64_tr_b16 v[196:197], v76 offset:62464
    v_mfma_f32_16x16x32_bf16 v[152:155], v[40:43], a[52:55], v[152:155]
    ds_read_b64_tr_b16 v[198:199], v76 offset:64512
    v_mfma_f32_16x16x32_bf16 v[156:159], v[176:179], a[52:55], v[156:159]
    ds_read_b64_tr_b16 v[200:201], v8 offset:62464
    v_mfma_f32_16x16x32_bf16 v[148:151], v[176:179], a[48:51], v[148:151]
    s_waitcnt lgkmcnt(7)
    ds_read_b64_tr_b16 v[202:203], v8 offset:64512
    v_mfma_f32_16x16x32_bf16 v[160:163], v[180:183], a[48:51], v[160:163]
    ds_read_b64_tr_b16 v[40:41], v29 offset:4096
    v_mfma_f32_16x16x32_bf16 v[168:171], v[180:183], a[52:55], v[168:171]
    s_add_u32 m0, s66, 114560
    ds_read_b64_tr_b16 v[42:43], v29 offset:6144
    buffer_load_dwordx4 v49, s[16:19], s55 offen offset:128 lds
    v_mfma_f32_16x16x32_bf16 v[172:175], v[184:187], a[52:55], v[172:175]
    ds_read_b64_tr_b16 v[176:177], v33 offset:4096
    v_mfma_f32_16x16x32_bf16 v[164:167], v[184:187], a[48:51], v[164:167]
    s_waitcnt lgkmcnt(7)
    ds_read_b64_tr_b16 v[178:179], v33 offset:6144
    v_mfma_f32_16x16x32_bf16 v[80:83], v[188:191], a[56:59], v[80:83]
    ds_read_b64_tr_b16 v[180:181], v29 offset:5120
    v_mfma_f32_16x16x32_bf16 v[88:91], v[188:191], a[60:63], v[88:91]
    ds_read_b64_tr_b16 v[182:183], v29 offset:7168
    buffer_load_dwordx4 a[104:107], v7, s[4:7], s92 offen offset:1024 sc1
    v_mfma_f32_16x16x32_bf16 v[92:95], v[192:195], a[60:63], v[92:95]
    ds_read_b64_tr_b16 v[184:185], v33 offset:5120
    v_mfma_f32_16x16x32_bf16 v[84:87], v[192:195], a[56:59], v[84:87]
    s_waitcnt lgkmcnt(7)
    ds_read_b64_tr_b16 v[186:187], v33 offset:7168
    v_mfma_f32_16x16x32_bf16 v[96:99], v[196:199], a[56:59], v[96:99]
    ds_read_b64_tr_b16 v[188:189], v29 offset:16384
    v_mfma_f32_16x16x32_bf16 v[104:107], v[196:199], a[60:63], v[104:107]
    ds_read_b64_tr_b16 v[190:191], v29 offset:18432
    buffer_load_dwordx4 a[108:111], v35, s[4:7], s92 offen offset:1024 sc1
    v_mfma_f32_16x16x32_bf16 v[108:111], v[200:203], a[60:63], v[108:111]
    s_add_u32 s92, s92, 2048
    s_and_b32 s92, s92, 0x3fff
    ds_read_b64_tr_b16 v[192:193], v33 offset:16384
    v_mfma_f32_16x16x32_bf16 v[100:103], v[200:203], a[56:59], v[100:103]
    s_waitcnt lgkmcnt(7)
    ds_read_b64_tr_b16 v[194:195], v33 offset:18432
    v_mfma_f32_16x16x32_bf16 v[80:83], v[40:43], a[64:67], v[80:83]
    ds_read_b64_tr_b16 v[196:197], v29 offset:17408
    v_mfma_f32_16x16x32_bf16 v[88:91], v[40:43], a[68:71], v[88:91]
    ds_read_b64_tr_b16 v[198:199], v29 offset:19456
    v_mfma_f32_16x16x32_bf16 v[92:95], v[176:179], a[68:71], v[92:95]
    ds_read_b64_tr_b16 v[200:201], v33 offset:17408
    v_mfma_f32_16x16x32_bf16 v[84:87], v[176:179], a[64:67], v[84:87]
    s_waitcnt lgkmcnt(7)
    ds_read_b64_tr_b16 v[202:203], v33 offset:19456
    v_mfma_f32_16x16x32_bf16 v[96:99], v[180:183], a[64:67], v[96:99]
    ds_read_b64_tr_b16 v[40:41], v29 offset:28672
    v_mfma_f32_16x16x32_bf16 v[104:107], v[180:183], a[68:71], v[104:107]
    ds_read_b64_tr_b16 v[42:43], v29 offset:30720
    buffer_load_dwordx4 a[112:115], v7, s[4:7], s92 offen offset:0 sc1
    v_mfma_f32_16x16x32_bf16 v[108:111], v[184:187], a[68:71], v[108:111]
    ds_read_b64_tr_b16 v[176:177], v33 offset:28672
    v_mfma_f32_16x16x32_bf16 v[100:103], v[184:187], a[64:67], v[100:103]
    s_waitcnt lgkmcnt(7)
    ds_read_b64_tr_b16 v[178:179], v33 offset:30720
    v_mfma_f32_16x16x32_bf16 v[80:83], v[188:191], a[72:75], v[80:83]
    ds_read_b64_tr_b16 v[180:181], v29 offset:29696
    v_mfma_f32_16x16x32_bf16 v[88:91], v[188:191], a[76:79], v[88:91]
    ds_read_b64_tr_b16 v[182:183], v29 offset:31744
    buffer_load_dwordx4 a[116:119], v35, s[4:7], s92 offen offset:0 sc1
    v_mfma_f32_16x16x32_bf16 v[92:95], v[192:195], a[76:79], v[92:95]
    ds_read_b64_tr_b16 v[184:185], v33 offset:29696
    v_mfma_f32_16x16x32_bf16 v[84:87], v[192:195], a[72:75], v[84:87]
    s_waitcnt lgkmcnt(7)
    ds_read_b64_tr_b16 v[186:187], v33 offset:31744
    v_mfma_f32_16x16x32_bf16 v[96:99], v[196:199], a[72:75], v[96:99]
    ds_read_b64_tr_b16 v[188:189], v9 offset:12288
    v_mfma_f32_16x16x32_bf16 v[104:107], v[196:199], a[76:79], v[104:107]
    ds_read_b64_tr_b16 v[190:191], v9 offset:14336
    buffer_load_dwordx4 a[120:123], v7, s[4:7], s92 offen offset:1024 sc1
    v_mfma_f32_16x16x32_bf16 v[108:111], v[200:203], a[76:79], v[108:111]
    ds_read_b64_tr_b16 v[192:193], v30 offset:12288
    v_mfma_f32_16x16x32_bf16 v[100:103], v[200:203], a[72:75], v[100:103]
    s_waitcnt lgkmcnt(7)
    ds_read_b64_tr_b16 v[194:195], v30 offset:14336
    s_waitcnt vmcnt(10)
    s_barrier
    v_mfma_f32_16x16x32_bf16 v[80:83], v[40:43], a[80:83], v[80:83]
    ds_read_b64_tr_b16 v[196:197], v9 offset:13312
    v_mfma_f32_16x16x32_bf16 v[88:91], v[40:43], a[84:87], v[88:91]
    ds_read_b64_tr_b16 v[198:199], v9 offset:15360
    v_mfma_f32_16x16x32_bf16 v[92:95], v[176:179], a[84:87], v[92:95]
    ds_read_b64_tr_b16 v[200:201], v30 offset:13312
    v_mfma_f32_16x16x32_bf16 v[84:87], v[176:179], a[80:83], v[84:87]
    s_waitcnt lgkmcnt(7)
    ds_read_b64_tr_b16 v[202:203], v30 offset:15360
    v_mfma_f32_16x16x32_bf16 v[96:99], v[180:183], a[80:83], v[96:99]
    ds_read_b64_tr_b16 v[40:41], v9 offset:24576
    v_mfma_f32_16x16x32_bf16 v[104:107], v[180:183], a[84:87], v[104:107]
    ds_read_b64_tr_b16 v[42:43], v9 offset:26624
    buffer_load_dwordx4 a[124:127], v35, s[4:7], s92 offen offset:1024 sc1
    v_mfma_f32_16x16x32_bf16 v[108:111], v[184:187], a[84:87], v[108:111]
    ds_read_b64_tr_b16 v[176:177], v30 offset:24576
    v_mfma_f32_16x16x32_bf16 v[100:103], v[184:187], a[80:83], v[100:103]
    s_waitcnt lgkmcnt(7)
    ds_read_b64_tr_b16 v[178:179], v30 offset:26624
    v_mfma_f32_16x16x32_bf16 v[80:83], v[188:191], a[88:91], v[80:83]
    s_mov_b32 s77, 0
    ds_read_b64_tr_b16 v[180:181], v9 offset:25600
    v_mfma_f32_16x16x32_bf16 v[88:91], v[188:191], a[92:95], v[88:91]
    s_add_u32 m0, s66, 118784
    ds_read_b64_tr_b16 v[182:183], v9 offset:27648
    buffer_load_dwordx4 v45, s[20:23], s77 offen lds
    v_mfma_f32_16x16x32_bf16 v[92:95], v[192:195], a[92:95], v[92:95]
    ds_read_b64_tr_b16 v[184:185], v30 offset:25600
    v_mfma_f32_16x16x32_bf16 v[84:87], v[192:195], a[88:91], v[84:87]
    s_waitcnt lgkmcnt(7)
    ds_read_b64_tr_b16 v[186:187], v30 offset:27648
    v_mfma_f32_16x16x32_bf16 v[96:99], v[196:199], a[88:91], v[96:99]
    s_mov_b32 s77, 16384
    ds_read_b64_tr_b16 v[188:189], v76 offset:12288
    v_mfma_f32_16x16x32_bf16 v[104:107], v[196:199], a[92:95], v[104:107]
    s_add_u32 m0, s66, 122880
    ds_read_b64_tr_b16 v[190:191], v76 offset:14336
    buffer_load_dwordx4 v45, s[20:23], s77 offen lds
    v_mfma_f32_16x16x32_bf16 v[108:111], v[200:203], a[92:95], v[108:111]
    ds_read_b64_tr_b16 v[192:193], v8 offset:12288
    v_mfma_f32_16x16x32_bf16 v[100:103], v[200:203], a[88:91], v[100:103]
    s_waitcnt lgkmcnt(7)
    ds_read_b64_tr_b16 v[194:195], v8 offset:14336
    s_waitcnt vmcnt(10)
    s_barrier
    v_mfma_f32_16x16x32_bf16 v[80:83], v[40:43], a[96:99], v[80:83]
    ds_read_b64_tr_b16 v[196:197], v76 offset:13312
    v_mfma_f32_16x16x32_bf16 v[88:91], v[40:43], a[100:103], v[88:91]
    ds_read_b64_tr_b16 v[198:199], v76 offset:15360
    v_add_f32 v220, v220, v222
    v_mfma_f32_16x16x32_bf16 v[92:95], v[176:179], a[100:103], v[92:95]
    ds_read_b64_tr_b16 v[200:201], v8 offset:13312
    v_add_f32 v221, v221, v223
    v_mfma_f32_16x16x32_bf16 v[84:87], v[176:179], a[96:99], v[84:87]
    s_waitcnt lgkmcnt(7)
    ds_read_b64_tr_b16 v[202:203], v8 offset:15360
    v_mov_b32 v223, 0x3727c5ac
    v_mfma_f32_16x16x32_bf16 v[96:99], v[180:183], a[96:99], v[96:99]
    s_mov_b32 s77, 196608
    ds_read_b64_tr_b16 v[40:41], v9 offset:28672
    v_permlane16_swap_b32 v220, v221
    v_mfma_f32_16x16x32_bf16 v[104:107], v[180:183], a[100:103], v[104:107]
    s_add_u32 m0, s66, 126976
    ds_read_b64_tr_b16 v[42:43], v9 offset:30720
    buffer_load_dwordx4 v45, s[20:23], s77 offen lds
    v_mfma_f32_16x16x32_bf16 v[108:111], v[184:187], a[100:103], v[108:111]
    ds_read_b64_tr_b16 v[176:177], v30 offset:28672
    v_add_f32 v222, v220, v221
    v_mfma_f32_16x16x32_bf16 v[100:103], v[184:187], a[96:99], v[100:103]
    s_waitcnt vmcnt(7) lgkmcnt(7)
    ds_read_b64_tr_b16 v[178:179], v30 offset:30720
    v_add_f32 v220, v220, v221
    v_mfma_f32_16x16x32_bf16 v[80:83], v[188:191], a[104:107], v[80:83]
    s_mov_b32 s77, 212992
    ds_read_b64_tr_b16 v[180:181], v9 offset:29696
    v_permlane32_swap_b32 v220, v222
    v_mfma_f32_16x16x32_bf16 v[88:91], v[188:191], a[108:111], v[88:91]
    s_add_u32 m0, s66, 45056
    ds_read_b64_tr_b16 v[182:183], v9 offset:31744
    buffer_load_dwordx4 v45, s[20:23], s77 offen lds
    v_mfma_f32_16x16x32_bf16 v[92:95], v[192:195], a[108:111], v[92:95]
    ds_read_b64_tr_b16 v[184:185], v30 offset:29696
    v_add_f32 v220, v220, v222
    v_mfma_f32_16x16x32_bf16 v[84:87], v[192:195], a[104:107], v[84:87]
    s_waitcnt lgkmcnt(7)
    ds_read_b64_tr_b16 v[186:187], v30 offset:31744
    v_fmamk_f32 v226, v220, 0x3b000000, v223
    v_mfma_f32_16x16x32_bf16 v[96:99], v[196:199], a[104:107], v[96:99]
    s_mov_b32 s77, 393216
    ds_read_b64_tr_b16 v[188:189], v9 offset:40960
    v_fmamk_f32 v227, v220, 0x3b000000, v223
    v_mfma_f32_16x16x32_bf16 v[104:107], v[196:199], a[108:111], v[104:107]
    s_add_u32 m0, s66, 49152
    ds_read_b64_tr_b16 v[190:191], v9 offset:43008
    buffer_load_dwordx4 v45, s[20:23], s77 offen lds
    v_mfma_f32_16x16x32_bf16 v[108:111], v[200:203], a[108:111], v[108:111]
    ds_read_b64_tr_b16 v[192:193], v30 offset:40960
    v_permlane16_swap_b32 v226, v227
    v_mfma_f32_16x16x32_bf16 v[100:103], v[200:203], a[104:107], v[100:103]
    s_waitcnt vmcnt(7) lgkmcnt(7)
    ds_read_b64_tr_b16 v[194:195], v30 offset:43008
    v_mfma_f32_16x16x32_bf16 v[80:83], v[40:43], a[112:115], v[80:83]
    ds_read_b64_tr_b16 v[196:197], v9 offset:41984
    v_rsq_f32 v220, v226
    v_mfma_f32_16x16x32_bf16 v[88:91], v[40:43], a[116:119], v[88:91]
    ds_read_b64_tr_b16 v[198:199], v9 offset:44032
    v_rcp_f32_e64 v221, v226
    v_mfma_f32_16x16x32_bf16 v[92:95], v[176:179], a[116:119], v[92:95]
    ds_read_b64_tr_b16 v[200:201], v30 offset:41984
    v_mfma_f32_16x16x32_bf16 v[84:87], v[176:179], a[112:115], v[84:87]
    s_waitcnt lgkmcnt(7)
    ds_read_b64_tr_b16 v[202:203], v30 offset:44032
    v_mfma_f32_16x16x32_bf16 v[96:99], v[180:183], a[112:115], v[96:99]
    s_mov_b32 s77, 409600
    ds_read_b64_tr_b16 v[40:41], v9 offset:0
    v_mul_f32 v78, 0xc0135761, v220
    v_mfma_f32_16x16x32_bf16 v[104:107], v[180:183], a[116:119], v[104:107]
    s_add_u32 m0, s66, 53248
    ds_read_b64_tr_b16 v[42:43], v9 offset:2048
    buffer_load_dwordx4 v45, s[20:23], s77 offen lds
    v_mfma_f32_16x16x32_bf16 v[108:111], v[184:187], a[116:119], v[108:111]
    ds_read_b64_tr_b16 v[176:177], v30 offset:0
    v_mul_f32 v224, 0x3d372713, v221
    v_mfma_f32_16x16x32_bf16 v[100:103], v[184:187], a[112:115], v[100:103]
    s_waitcnt vmcnt(6) lgkmcnt(7)
    ds_read_b64_tr_b16 v[178:179], v30 offset:2048
    v_mul_f32_e64 v224, v224, v78
    v_mfma_f32_16x16x32_bf16 v[80:83], v[188:191], a[120:123], v[80:83]
    s_mov_b32 s77, 589824
    ds_read_b64_tr_b16 v[180:181], v9 offset:1024
    v_rsq_f32 v220, v227
    v_mfma_f32_16x16x32_bf16 v[88:91], v[188:191], a[124:127], v[88:91]
    s_add_u32 m0, s66, 24576
    ds_read_b64_tr_b16 v[182:183], v9 offset:3072
    buffer_load_dwordx4 v45, s[20:23], s77 offen lds
    v_mfma_f32_16x16x32_bf16 v[92:95], v[192:195], a[124:127], v[92:95]
    ds_read_b64_tr_b16 v[184:185], v30 offset:1024
    v_rcp_f32 v221, v227
    v_mfma_f32_16x16x32_bf16 v[84:87], v[192:195], a[120:123], v[84:87]
    s_waitcnt lgkmcnt(7)
    ds_read_b64_tr_b16 v[186:187], v30 offset:3072
    v_mfma_f32_16x16x32_bf16 v[96:99], v[196:199], a[120:123], v[96:99]
    s_mov_b32 s77, 606208
    ds_read_b64_tr_b16 v[188:189], v29 offset:8192
    v_mul_f32 v79, 0xc0135761, v220
    v_mfma_f32_16x16x32_bf16 v[104:107], v[196:199], a[124:127], v[104:107]
    s_add_u32 m0, s66, 28672
    ds_read_b64_tr_b16 v[190:191], v29 offset:10240
    buffer_load_dwordx4 v45, s[20:23], s77 offen lds
    v_mfma_f32_16x16x32_bf16 v[108:111], v[200:203], a[124:127], v[108:111]
    ds_read_b64_tr_b16 v[192:193], v33 offset:8192
    v_mul_f32 v225, 0x3d372713, v221
    v_mfma_f32_16x16x32_bf16 v[100:103], v[200:203], a[120:123], v[100:103]
    s_waitcnt lgkmcnt(7)
    ds_read_b64_tr_b16 v[194:195], v33 offset:10240
    v_mul_f32_e64 v225, v225, v79
    v_mfma_f32_16x16x32_bf16 v[112:115], v[40:43], a[56:59], v[112:115]
    ds_read_b64_tr_b16 v[196:197], v29 offset:9216
    v_mfma_f32_16x16x32_bf16 v[120:123], v[40:43], a[60:63], v[120:123]
    ds_read_b64_tr_b16 v[198:199], v29 offset:11264
    v_mfma_f32_16x16x32_bf16 v[124:127], v[176:179], a[60:63], v[124:127]
    ds_read_b64_tr_b16 v[200:201], v33 offset:9216
    v_mfma_f32_16x16x32_bf16 v[116:119], v[176:179], a[56:59], v[116:119]
    s_nop 0
    s_waitcnt lgkmcnt(7)
    ds_read_b64_tr_b16 v[202:203], v33 offset:11264
    v_pk_mul_f32 v[228:229], v[80:81], v[80:81]
    s_add_u32 m0, s66, 32768
    s_mov_b32 s77, 786432
    buffer_load_dwordx4 v45, s[20:23], s77 offen lds
    v_pk_mul_f32 v[230:231], v[82:83], v[82:83]
    v_pk_fma_f32 v[228:229], v[228:229], v[224:225], v[78:79] op_sel:[0,0,0] op_sel_hi:[1,0,0]
L_warm_4:
    s_cbranch_execz L_warm_back
    v_pk_fma_f32 v[230:231], v[230:231], v[224:225], v[78:79] op_sel:[0,0,0] op_sel_hi:[1,0,0]
    v_pk_mul_f32 v[228:229], v[228:229], v[80:81]
    v_pk_mul_f32 v[230:231], v[230:231], v[82:83]
    v_exp_f32 v228, v228
    v_exp_f32 v229, v229
    v_exp_f32 v230, v230
    v_exp_f32_e64 v231, v231
    v_pk_mul_f32 v[96:97], v[96:97], v[80:81]
    v_pk_mul_f32 v[98:99], v[98:99], v[82:83]
    v_pk_fma_f32 v[228:229], v[228:229], v[226:227], v[226:227] op_sel:[0,0,0] op_sel_hi:[1,0,0]
    v_pk_fma_f32 v[230:231], v[230:231], v[226:227], v[226:227] op_sel:[0,0,0] op_sel_hi:[1,0,0]
    v_rcp_f32 v228, v228
    v_rcp_f32 v229, v229
    v_rcp_f32 v230, v230
    v_rcp_f32 v231, v231
    v_pk_mul_f32 v[96:97], v[96:97], v[228:229]
    v_pk_mul_f32 v[98:99], v[98:99], v[230:231]
    v_cvt_pk_bf16_f32 v236, v96, v97
    v_cvt_pk_bf16_f32 v237, v98, v99
    v_pk_mul_f32 v[232:233], v[84:85], v[84:85]
    s_add_u32 m0, s66, 0
    s_mov_b32 s77, 802816
    buffer_load_dwordx4 v45, s[20:23], s77 offen lds
    v_pk_mul_f32 v[234:235], v[86:87], v[86:87]
    v_pk_fma_f32 v[232:233], v[232:233], v[224:225], v[78:79] op_sel:[0,0,0] op_sel_hi:[1,0,0]
    v_pk_fma_f32 v[234:235], v[234:235], v[224:225], v[78:79] op_sel:[0,0,0] op_sel_hi:[1,0,0]
    v_pk_mul_f32 v[232:233], v[232:233], v[84:85]
    v_pk_mul_f32 v[234:235], v[234:235], v[86:87]
    v_exp_f32 v232, v232
    v_exp_f32 v233, v233
    v_exp_f32 v234, v234
    v_exp_f32_e64 v235, v235
    v_pk_mul_f32 v[100:101], v[100:101], v[84:85]
    v_pk_mul_f32 v[102:103], v[102:103], v[86:87]
    v_pk_fma_f32 v[232:233], v[232:233], v[226:227], v[226:227] op_sel:[0,0,0] op_sel_hi:[1,0,0]
    v_pk_fma_f32 v[234:235], v[234:235], v[226:227], v[226:227] op_sel:[0,0,0] op_sel_hi:[1,0,0]
    v_rcp_f32 v232, v232
    v_rcp_f32 v233, v233
    v_rcp_f32 v234, v234
    v_rcp_f32 v235, v235
    v_pk_mul_f32 v[100:101], v[100:101], v[232:233]
    v_pk_mul_f32 v[102:103], v[102:103], v[234:235]
    v_cvt_pk_bf16_f32 v238, v100, v101
    v_cvt_pk_bf16_f32 v239, v102, v103
    s_add_u32 s73, s91, 262144
    buffer_store_dwordx4 v[236:239], v17, s[32:35], s73 offen sc1
    v_pk_mul_f32 v[228:229], v[88:89], v[88:89]
    s_add_u32 m0, s66, 36864
    s_mov_b32 s77, 983040
    buffer_load_dwordx4 v45, s[20:23], s77 offen lds
    v_pk_mul_f32 v[230:231], v[90:91], v[90:91]
    v_pk_fma_f32 v[228:229], v[228:229], v[224:225], v[78:79] op_sel:[0,1,1] op_sel_hi:[1,1,1]
    v_pk_fma_f32 v[230:231], v[230:231], v[224:225], v[78:79] op_sel:[0,1,1] op_sel_hi:[1,1,1]
    v_pk_mul_f32 v[228:229], v[228:229], v[88:89]
    v_pk_mul_f32 v[230:231], v[230:231], v[90:91]
    v_exp_f32 v228, v228
    v_exp_f32 v229, v229
    v_exp_f32 v230, v230
    v_exp_f32 v231, v231
    v_pk_mul_f32 v[104:105], v[104:105], v[88:89]
    v_pk_mul_f32 v[106:107], v[106:107], v[90:91]
    v_pk_fma_f32 v[228:229], v[228:229], v[226:227], v[226:227] op_sel:[0,1,1] op_sel_hi:[1,1,1]
    v_pk_fma_f32 v[230:231], v[230:231], v[226:227], v[226:227] op_sel:[0,1,1] op_sel_hi:[1,1,1]
    v_rcp_f32 v228, v228
    v_rcp_f32 v229, v229
    v_rcp_f32 v230, v230
    v_rcp_f32 v231, v231
    v_pk_mul_f32 v[104:105], v[104:105], v[228:229]
    v_pk_mul_f32 v[106:107], v[106:107], v[230:231]
    v_cvt_pk_bf16_f32 v240, v104, v105
    v_cvt_pk_bf16_f32 v241, v106, v107
    v_pk_mul_f32 v[232:233], v[92:93], v[92:93]
    s_add_u32 m0, s66, 40960
    s_mov_b32 s77, 999424
    buffer_load_dwordx4 v45, s[20:23], s77 offen lds
    v_pk_mul_f32 v[234:235], v[94:95], v[94:95]
    v_pk_fma_f32 v[232:233], v[232:233], v[224:225], v[78:79] op_sel:[0,1,1] op_sel_hi:[1,1,1]
    v_pk_fma_f32 v[234:235], v[234:235], v[224:225], v[78:79] op_sel:[0,1,1] op_sel_hi:[1,1,1]
    v_pk_mul_f32 v[232:233], v[232:233], v[92:93]
    v_pk_mul_f32 v[234:235], v[234:235], v[94:95]
    v_exp_f32 v232, v232
    v_exp_f32 v233, v233
    v_exp_f32 v234, v234
    v_exp_f32 v235, v235
    v_pk_mul_f32 v[108:109], v[108:109], v[92:93]
    v_pk_mul_f32 v[110:111], v[110:111], v[94:95]
    v_pk_fma_f32 v[232:233], v[232:233], v[226:227], v[226:227] op_sel:[0,1,1] op_sel_hi:[1,1,1]
    v_pk_fma_f32 v[234:235], v[234:235], v[226:227], v[226:227] op_sel:[0,1,1] op_sel_hi:[1,1,1]
    v_rcp_f32 v232, v232
    v_rcp_f32 v233, v233
    v_rcp_f32 v234, v234
    v_rcp_f32 v235, v235
    v_pk_mul_f32 v[108:109], v[108:109], v[232:233]
    v_pk_mul_f32 v[110:111], v[110:111], v[234:235]
    v_cvt_pk_bf16_f32 v242, v108, v109
    v_cvt_pk_bf16_f32 v243, v110, v111
    s_add_u32 s73, s91, 278528
    buffer_store_dwordx4 v[240:243], v17, s[32:35], s73 offen sc1
    v_mfma_f32_16x16x32_bf16 v[128:131], v[180:183], a[56:59], v[128:131]
    s_mov_b32 s77, 1179648
    ds_read_b64_tr_b16 v[40:41], v29 offset:20480
    v_mfma_f32_16x16x32_bf16 v[136:139], v[180:183], a[60:63], v[136:139]
    s_add_u32 m0, s66, 57344
    ds_read_b64_tr_b16 v[42:43], v29 offset:22528
    buffer_load_dwordx4 v45, s[20:23], s77 offen lds
    v_mfma_f32_16x16x32_bf16 v[140:143], v[184:187], a[60:63], v[140:143]
    ds_read_b64_tr_b16 v[176:177], v33 offset:20480
    v_mfma_f32_16x16x32_bf16 v[132:135], v[184:187], a[56:59], v[132:135]
    s_waitcnt lgkmcnt(7)
    ds_read_b64_tr_b16 v[178:179], v33 offset:22528
    v_mfma_f32_16x16x32_bf16 v[112:115], v[188:191], a[64:67], v[112:115]
    s_mov_b32 s77, 1196032
    ds_read_b64_tr_b16 v[180:181], v29 offset:21504
    v_mfma_f32_16x16x32_bf16 v[120:123], v[188:191], a[68:71], v[120:123]
    s_add_u32 m0, s66, 61440
    ds_read_b64_tr_b16 v[182:183], v29 offset:23552
    buffer_load_dwordx4 v45, s[20:23], s77 offen lds
    v_mfma_f32_16x16x32_bf16 v[124:127], v[192:195], a[68:71], v[124:127]
    ds_read_b64_tr_b16 v[184:185], v33 offset:21504
    v_mfma_f32_16x16x32_bf16 v[116:119], v[192:195], a[64:67], v[116:119]
    s_waitcnt lgkmcnt(7)
    ds_read_b64_tr_b16 v[186:187], v33 offset:23552
    v_mfma_f32_16x16x32_bf16 v[128:131], v[196:199], a[64:67], v[128:131]
    s_mov_b32 s77, 1376256
    ds_read_b64_tr_b16 v[188:189], v9 offset:4096
    v_mfma_f32_16x16x32_bf16 v[136:139], v[196:199], a[68:71], v[136:139]
    s_add_u32 m0, s66, 135168
    ds_read_b64_tr_b16 v[190:191], v9 offset:6144
    buffer_load_dwordx4 v45, s[20:23], s77 offen lds
    v_mfma_f32_16x16x32_bf16 v[140:143], v[200:203], a[68:71], v[140:143]
    ds_read_b64_tr_b16 v[192:193], v30 offset:4096
    v_mfma_f32_16x16x32_bf16 v[132:135], v[200:203], a[64:67], v[132:135]
    s_waitcnt lgkmcnt(7)
    ds_read_b64_tr_b16 v[194:195], v30 offset:6144
    v_mfma_f32_16x16x32_bf16 v[112:115], v[40:43], a[72:75], v[112:115]
    s_mov_b32 s77, 1392640
    ds_read_b64_tr_b16 v[196:197], v9 offset:5120
    v_mfma_f32_16x16x32_bf16 v[120:123], v[40:43], a[76:79], v[120:123]
    s_add_u32 m0, s66, 147456
    ds_read_b64_tr_b16 v[198:199], v9 offset:7168
    buffer_load_dwordx4 v45, s[20:23], s77 offen lds
    v_mfma_f32_16x16x32_bf16 v[124:127], v[176:179], a[76:79], v[124:127]
    ds_read_b64_tr_b16 v[200:201], v30 offset:5120
    v_mfma_f32_16x16x32_bf16 v[116:119], v[176:179], a[72:75], v[116:119]
    s_waitcnt lgkmcnt(7)
    ds_read_b64_tr_b16 v[202:203], v30 offset:7168
    v_mfma_f32_16x16x32_bf16 v[128:131], v[180:183], a[72:75], v[128:131]
    s_add_u32 m0, s66, 159744
    s_mov_b32 s77, 32768
    ds_read_b64_tr_b16 v[40:41], v9 offset:16384
    buffer_load_dwordx4 v45, s[20:23], s77 offen lds
    v_mfma_f32_16x16x32_bf16 v[136:139], v[180:183], a[76:79], v[136:139]
    s_add_u32 m0, s66, 77824
    s_mov_b32 s77, 49152
    ds_read_b64_tr_b16 v[42:43], v9 offset:18432
    buffer_load_dwordx4 v45, s[20:23], s77 offen lds
    v_mfma_f32_16x16x32_bf16 v[140:143], v[184:187], a[76:79], v[140:143]
    ds_read_b64_tr_b16 v[176:177], v30 offset:16384
    v_mfma_f32_16x16x32_bf16 v[132:135], v[184:187], a[72:75], v[132:135]
    s_waitcnt lgkmcnt(7)
    ds_read_b64_tr_b16 v[178:179], v30 offset:18432
    v_mfma_f32_16x16x32_bf16 v[112:115], v[188:191], a[80:83], v[112:115]
    ds_read_b64_tr_b16 v[180:181], v9 offset:17408
    v_mfma_f32_16x16x32_bf16 v[120:123], v[188:191], a[84:87], v[120:123]
    ds_read_b64_tr_b16 v[182:183], v9 offset:19456
    v_mfma_f32_16x16x32_bf16 v[124:127], v[192:195], a[84:87], v[124:127]
    ds_read_b64_tr_b16 v[184:185], v30 offset:17408
    v_mfma_f32_16x16x32_bf16 v[116:119], v[192:195], a[80:83], v[116:119]
    s_waitcnt lgkmcnt(7)
    ds_read_b64_tr_b16 v[186:187], v30 offset:19456
    v_mfma_f32_16x16x32_bf16 v[128:131], v[196:199], a[80:83], v[128:131]
    ds_read_b64_tr_b16 v[188:189], v76 offset:4096
    v_mfma_f32_16x16x32_bf16 v[136:139], v[196:199], a[84:87], v[136:139]
    ds_read_b64_tr_b16 v[190:191], v76 offset:6144
    v_mfma_f32_16x16x32_bf16 v[140:143], v[200:203], a[84:87], v[140:143]
    ds_read_b64_tr_b16 v[192:193], v8 offset:4096
    v_mfma_f32_16x16x32_bf16 v[132:135], v[200:203], a[80:83], v[132:135]
    s_waitcnt lgkmcnt(7)
    ds_read_b64_tr_b16 v[194:195], v8 offset:6144
    v_mfma_f32_16x16x32_bf16 v[112:115], v[40:43], a[88:91], v[112:115]
    ds_read_b64_tr_b16 v[196:197], v76 offset:5120
    v_mfma_f32_16x16x32_bf16 v[120:123], v[40:43], a[92:95], v[120:123]
    ds_read_b64_tr_b16 v[198:199], v76 offset:7168
    v_mfma_f32_16x16x32_bf16 v[124:127], v[176:179], a[92:95], v[124:127]
    ds_read_b64_tr_b16 v[200:201], v8 offset:5120
    v_mfma_f32_16x16x32_bf16 v[116:119], v[176:179], a[88:91], v[116:119]
    s_waitcnt lgkmcnt(7)
    ds_read_b64_tr_b16 v[202:203], v8 offset:7168
    v_mfma_f32_16x16x32_bf16 v[128:131], v[180:183], a[88:91], v[128:131]
    ds_read_b64_tr_b16 v[40:41], v76 offset:16384
    v_mfma_f32_16x16x32_bf16 v[136:139], v[180:183], a[92:95], v[136:139]
    ds_read_b64_tr_b16 v[42:43], v76 offset:18432
    v_mfma_f32_16x16x32_bf16 v[140:143], v[184:187], a[92:95], v[140:143]
    ds_read_b64_tr_b16 v[176:177], v8 offset:16384
    v_mfma_f32_16x16x32_bf16 v[132:135], v[184:187], a[88:91], v[132:135]
    s_waitcnt lgkmcnt(7)
    ds_read_b64_tr_b16 v[178:179], v8 offset:18432
    v_mfma_f32_16x16x32_bf16 v[112:115], v[188:191], a[96:99], v[112:115]
    ds_read_b64_tr_b16 v[180:181], v76 offset:17408
    v_mfma_f32_16x16x32_bf16 v[120:123], v[188:191], a[100:103], v[120:123]
    ds_read_b64_tr_b16 v[182:183], v76 offset:19456
    v_mfma_f32_16x16x32_bf16 v[124:127], v[192:195], a[100:103], v[124:127]
    ds_read_b64_tr_b16 v[184:185], v8 offset:17408
    v_mfma_f32_16x16x32_bf16 v[116:119], v[192:195], a[96:99], v[116:119]
    s_waitcnt lgkmcnt(7)
    ds_read_b64_tr_b16 v[186:187], v8 offset:19456
    v_mfma_f32_16x16x32_bf16 v[128:131], v[196:199], a[96:99], v[128:131]
    ds_read_b64_tr_b16 v[188:189], v9 offset:32768
    v_mfma_f32_16x16x32_bf16 v[136:139], v[196:199], a[100:103], v[136:139]
    ds_read_b64_tr_b16 v[190:191], v9 offset:34816
    v_mfma_f32_16x16x32_bf16 v[140:143], v[200:203], a[100:103], v[140:143]
    ds_read_b64_tr_b16 v[192:193], v30 offset:32768
    v_mfma_f32_16x16x32_bf16 v[132:135], v[200:203], a[96:99], v[132:135]
    s_waitcnt lgkmcnt(7)
    ds_read_b64_tr_b16 v[194:195], v30 offset:34816
    s_waitcnt vmcnt(10)
    s_barrier
    s_waitcnt vmcnt(6)
    s_cmp_lg_u32 s60, 0
    s_cbranch_scc1 L_slowsig_13
    s_mov_b64 exec, 4
    buffer_store_dword v74, v69, s[32:35], 0 offen
    s_mov_b64 exec, -1
L_sigback_14:
    v_mfma_f32_16x16x32_bf16 v[112:115], v[40:43], a[104:107], v[112:115]
    s_mov_b32 s77, 229376
    ds_read_b64_tr_b16 v[196:197], v9 offset:33792
    v_mfma_f32_16x16x32_bf16 v[120:123], v[40:43], a[108:111], v[120:123]
    s_add_u32 m0, s66, 90112
    ds_read_b64_tr_b16 v[198:199], v9 offset:35840
    buffer_load_dwordx4 v45, s[20:23], s77 offen lds
    v_mfma_f32_16x16x32_bf16 v[124:127], v[176:179], a[108:111], v[124:127]
    ds_read_b64_tr_b16 v[200:201], v30 offset:33792
    v_mfma_f32_16x16x32_bf16 v[116:119], v[176:179], a[104:107], v[116:119]
    s_waitcnt lgkmcnt(7)
    ds_read_b64_tr_b16 v[202:203], v30 offset:35840
    v_mfma_f32_16x16x32_bf16 v[128:131], v[180:183], a[104:107], v[128:131]
    s_add_u32 m0, s66, 12288
    s_mov_b32 s77, 245760
    ds_read_b64_tr_b16 v[40:41], v9 offset:45056
    buffer_load_dwordx4 v45, s[20:23], s77 offen lds
    v_mfma_f32_16x16x32_bf16 v[136:139], v[180:183], a[108:111], v[136:139]
    s_add_u32 m0, s66, 94208
    s_mov_b32 s77, 425984
    ds_read_b64_tr_b16 v[42:43], v9 offset:47104
    buffer_load_dwordx4 v45, s[20:23], s77 offen lds
    v_mfma_f32_16x16x32_bf16 v[140:143], v[184:187], a[108:111], v[140:143]
    ds_read_b64_tr_b16 v[176:177], v30 offset:45056
    v_mfma_f32_16x16x32_bf16 v[132:135], v[184:187], a[104:107], v[132:135]
    s_waitcnt lgkmcnt(7)
    ds_read_b64_tr_b16 v[178:179], v30 offset:47104
    v_mfma_f32_16x16x32_bf16 v[112:115], v[188:191], a[112:115], v[112:115]
    s_mov_b32 s77, 442368
    ds_read_b64_tr_b16 v[180:181], v9 offset:46080
    v_mfma_f32_16x16x32_bf16 v[120:123], v[188:191], a[116:119], v[120:123]
    s_add_u32 m0, s66, 106496
    ds_read_b64_tr_b16 v[182:183], v9 offset:48128
    buffer_load_dwordx4 v45, s[20:23], s77 offen lds
    v_mfma_f32_16x16x32_bf16 v[124:127], v[192:195], a[116:119], v[124:127]
    ds_read_b64_tr_b16 v[184:185], v30 offset:46080
    v_mfma_f32_16x16x32_bf16 v[116:119], v[192:195], a[112:115], v[116:119]
    s_waitcnt lgkmcnt(7)
    ds_read_b64_tr_b16 v[186:187], v30 offset:48128
    v_mfma_f32_16x16x32_bf16 v[128:131], v[196:199], a[112:115], v[128:131]
    s_add_u32 m0, s66, 65536
    s_mov_b32 s77, 622592
    ds_read_b64_tr_b16 v[188:189], v29 offset:0
    buffer_load_dwordx4 v45, s[20:23], s77 offen lds
    v_mfma_f32_16x16x32_bf16 v[136:139], v[196:199], a[116:119], v[136:139]
    s_add_u32 m0, s66, 139264
    s_mov_b32 s77, 638976
    ds_read_b64_tr_b16 v[190:191], v29 offset:2048
    buffer_load_dwordx4 v45, s[20:23], s77 offen lds
    v_mfma_f32_16x16x32_bf16 v[140:143], v[200:203], a[116:119], v[140:143]
    ds_read_b64_tr_b16 v[192:193], v33 offset:0
    v_mfma_f32_16x16x32_bf16 v[132:135], v[200:203], a[112:115], v[132:135]
    s_waitcnt lgkmcnt(7)
    ds_read_b64_tr_b16 v[194:195], v33 offset:2048
    v_mfma_f32_16x16x32_bf16 v[112:115], v[40:43], a[120:123], v[112:115]
    s_mov_b32 s77, 819200
    ds_read_b64_tr_b16 v[196:197], v29 offset:1024
    v_mfma_f32_16x16x32_bf16 v[120:123], v[40:43], a[124:127], v[120:123]
    s_add_u32 m0, s66, 151552
    ds_read_b64_tr_b16 v[198:199], v29 offset:3072
    buffer_load_dwordx4 v45, s[20:23], s77 offen lds
    v_mfma_f32_16x16x32_bf16 v[124:127], v[176:179], a[124:127], v[124:127]
    ds_read_b64_tr_b16 v[200:201], v33 offset:1024
    v_mfma_f32_16x16x32_bf16 v[116:119], v[176:179], a[120:123], v[116:119]
    s_waitcnt lgkmcnt(7)
    ds_read_b64_tr_b16 v[202:203], v33 offset:3072
    v_mfma_f32_16x16x32_bf16 v[128:131], v[180:183], a[120:123], v[128:131]
    s_add_u32 m0, s66, 69632
    s_mov_b32 s77, 835584
    ds_read_b64_tr_b16 v[40:41], v29 offset:12288
    buffer_load_dwordx4 v45, s[20:23], s77 offen lds
    v_mfma_f32_16x16x32_bf16 v[136:139], v[180:183], a[124:127], v[136:139]
    s_add_u32 m0, s66, 81920
    s_mov_b32 s77, 1015808
    ds_read_b64_tr_b16 v[42:43], v29 offset:14336
    buffer_load_dwordx4 v45, s[20:23], s77 offen lds
    v_mfma_f32_16x16x32_bf16 v[140:143], v[184:187], a[124:127], v[140:143]
    ds_read_b64_tr_b16 v[176:177], v33 offset:12288
    v_mfma_f32_16x16x32_bf16 v[132:135], v[184:187], a[120:123], v[132:135]
    s_waitcnt lgkmcnt(7)
    ds_read_b64_tr_b16 v[178:179], v33 offset:14336
    v_mfma_f32_16x16x32_bf16 v[144:147], v[188:191], a[56:59], v[144:147]
    ds_read_b64_tr_b16 v[180:181], v29 offset:13312
    v_mfma_f32_16x16x32_bf16 v[152:155], v[188:191], a[60:63], v[152:155]
    ds_read_b64_tr_b16 v[182:183], v29 offset:15360
    buffer_load_dword v10, v73, s[32:35], 0 offen offset:1024 sc1
    v_mfma_f32_16x16x32_bf16 v[156:159], v[192:195], a[60:63], v[156:159]
    ds_read_b64_tr_b16 v[184:185], v33 offset:13312
    v_mfma_f32_16x16x32_bf16 v[148:151], v[192:195], a[56:59], v[148:151]
    s_nop 0
    s_waitcnt lgkmcnt(7)
    ds_read_b64_tr_b16 v[186:187], v33 offset:15360
    v_pk_mul_f32 v[228:229], v[112:113], v[112:113]
    s_add_u32 m0, s66, 4096
    s_mov_b32 s77, 1032192
    buffer_load_dwordx4 v45, s[20:23], s77 offen lds
    v_pk_mul_f32 v[230:231], v[114:115], v[114:115]
    v_pk_fma_f32 v[228:229], v[228:229], v[224:225], v[78:79] op_sel:[0,0,0] op_sel_hi:[1,0,0]
    v_pk_fma_f32 v[230:231], v[230:231], v[224:225], v[78:79] op_sel:[0,0,0] op_sel_hi:[1,0,0]
    v_pk_mul_f32 v[228:229], v[228:229], v[112:113]
    v_pk_mul_f32 v[230:231], v[230:231], v[114:115]
    v_exp_f32 v228, v228
    v_exp_f32 v229, v229
    v_exp_f32 v230, v230
    v_exp_f32 v231, v231
    v_pk_mul_f32 v[128:129], v[128:129], v[112:113]
    v_pk_mul_f32 v[130:131], v[130:131], v[114:115]
    v_pk_fma_f32 v[228:229], v[228:229], v[226:227], v[226:227] op_sel:[0,0,0] op_sel_hi:[1,0,0]
    v_pk_fma_f32 v[230:231], v[230:231], v[226:227], v[226:227] op_sel:[0,0,0] op_sel_hi:[1,0,0]
    v_rcp_f32 v228, v228
    v_rcp_f32 v229, v229
    v_rcp_f32 v230, v230
    v_rcp_f32 v231, v231
    v_pk_mul_f32 v[128:129], v[128:129], v[228:229]
    v_pk_mul_f32 v[130:131], v[130:131], v[230:231]
    v_cvt_pk_bf16_f32 v236, v128, v129
    v_cvt_pk_bf16_f32 v237, v130, v131
    v_pk_mul_f32 v[232:233], v[116:117], v[116:117]
    v_pk_mul_f32 v[234:235], v[118:119], v[118:119]
    v_pk_fma_f32 v[232:233], v[232:233], v[224:225], v[78:79] op_sel:[0,0,0] op_sel_hi:[1,0,0]
    v_pk_fma_f32 v[234:235], v[234:235], v[224:225], v[78:79] op_sel:[0,0,0] op_sel_hi:[1,0,0]
    v_pk_mul_f32 v[232:233], v[232:233], v[116:117]
    v_pk_mul_f32 v[234:235], v[234:235], v[118:119]
    v_exp_f32 v232, v232
    v_exp_f32 v233, v233
    v_exp_f32 v234, v234
    v_exp_f32 v235, v235
    v_pk_mul_f32 v[132:133], v[132:133], v[116:117]
    v_pk_mul_f32 v[134:135], v[134:135], v[118:119]
    v_pk_fma_f32 v[232:233], v[232:233], v[226:227], v[226:227] op_sel:[0,0,0] op_sel_hi:[1,0,0]
    v_pk_fma_f32 v[234:235], v[234:235], v[226:227], v[226:227] op_sel:[0,0,0] op_sel_hi:[1,0,0]
    v_rcp_f32 v232, v232
    v_rcp_f32 v233, v233
    v_rcp_f32 v234, v234
    v_rcp_f32 v235, v235
    v_pk_mul_f32 v[132:133], v[132:133], v[232:233]
    v_pk_mul_f32 v[134:135], v[134:135], v[234:235]
    v_cvt_pk_bf16_f32 v238, v132, v133
    v_cvt_pk_bf16_f32 v239, v134, v135
    s_add_u32 s73, s91, 393216
    buffer_store_dwordx4 v[236:239], v17, s[32:35], s73 offen sc1
    v_pk_mul_f32 v[228:229], v[120:121], v[120:121]
    v_pk_mul_f32 v[230:231], v[122:123], v[122:123]
    v_pk_fma_f32 v[228:229], v[228:229], v[224:225], v[78:79] op_sel:[0,1,1] op_sel_hi:[1,1,1]
    v_pk_fma_f32 v[230:231], v[230:231], v[224:225], v[78:79] op_sel:[0,1,1] op_sel_hi:[1,1,1]
    v_pk_mul_f32 v[228:229], v[228:229], v[120:121]
    v_pk_mul_f32 v[230:231], v[230:231], v[122:123]
    v_exp_f32 v228, v228
    v_exp_f32 v229, v229
    v_exp_f32 v230, v230
    v_exp_f32 v231, v231
    v_pk_mul_f32 v[136:137], v[136:137], v[120:121]
    v_pk_mul_f32 v[138:139], v[138:139], v[122:123]
    v_pk_fma_f32 v[228:229], v[228:229], v[226:227], v[226:227] op_sel:[0,1,1] op_sel_hi:[1,1,1]
    v_pk_fma_f32 v[230:231], v[230:231], v[226:227], v[226:227] op_sel:[0,1,1] op_sel_hi:[1,1,1]
    v_rcp_f32 v228, v228
    v_rcp_f32 v229, v229
    v_rcp_f32 v230, v230
    v_rcp_f32 v231, v231
    v_pk_mul_f32 v[136:137], v[136:137], v[228:229]
    v_pk_mul_f32 v[138:139], v[138:139], v[230:231]
    v_cvt_pk_bf16_f32 v240, v136, v137
    v_cvt_pk_bf16_f32 v241, v138, v139
    v_pk_mul_f32 v[232:233], v[124:125], v[124:125]
    v_pk_mul_f32 v[234:235], v[126:127], v[126:127]
    v_pk_fma_f32 v[232:233], v[232:233], v[224:225], v[78:79] op_sel:[0,1,1] op_sel_hi:[1,1,1]
    v_pk_fma_f32 v[234:235], v[234:235], v[224:225], v[78:79] op_sel:[0,1,1] op_sel_hi:[1,1,1]
    v_pk_mul_f32 v[232:233], v[232:233], v[124:125]
    v_pk_mul_f32 v[234:235], v[234:235], v[126:127]
    v_exp_f32 v232, v232
    v_exp_f32 v233, v233
    v_exp_f32 v234, v234
    v_exp_f32 v235, v235
    v_pk_mul_f32 v[140:141], v[140:141], v[124:125]
    v_pk_mul_f32 v[142:143], v[142:143], v[126:127]
    v_pk_fma_f32 v[232:233], v[232:233], v[226:227], v[226:227] op_sel:[0,1,1] op_sel_hi:[1,1,1]
    v_pk_fma_f32 v[234:235], v[234:235], v[226:227], v[226:227] op_sel:[0,1,1] op_sel_hi:[1,1,1]
    v_rcp_f32 v232, v232
    v_rcp_f32 v233, v233
    v_rcp_f32 v234, v234
    v_rcp_f32 v235, v235
    v_pk_mul_f32 v[140:141], v[140:141], v[232:233]
    v_pk_mul_f32 v[142:143], v[142:143], v[234:235]
    v_cvt_pk_bf16_f32 v242, v140, v141
    v_cvt_pk_bf16_f32 v243, v142, v143
    s_add_u32 s73, s91, 409600
    buffer_store_dwordx4 v[240:243], v17, s[32:35], s73 offen sc1
    v_mfma_f32_16x16x32_bf16 v[160:163], v[196:199], a[56:59], v[160:163]
    ds_read_b64_tr_b16 v[188:189], v29 offset:24576
    v_mfma_f32_16x16x32_bf16 v[168:171], v[196:199], a[60:63], v[168:171]
    ds_read_b64_tr_b16 v[190:191], v29 offset:26624
    v_mfma_f32_16x16x32_bf16 v[172:175], v[200:203], a[60:63], v[172:175]
    ds_read_b64_tr_b16 v[192:193], v33 offset:24576
    v_mfma_f32_16x16x32_bf16 v[164:167], v[200:203], a[56:59], v[164:167]
    s_waitcnt lgkmcnt(7)
    ds_read_b64_tr_b16 v[194:195], v33 offset:26624
    v_mfma_f32_16x16x32_bf16 v[144:147], v[40:43], a[64:67], v[144:147]
    ds_read_b64_tr_b16 v[196:197], v29 offset:25600
    v_mfma_f32_16x16x32_bf16 v[152:155], v[40:43], a[68:71], v[152:155]
    ds_read_b64_tr_b16 v[198:199], v29 offset:27648
    v_mfma_f32_16x16x32_bf16 v[156:159], v[176:179], a[68:71], v[156:159]
    ds_read_b64_tr_b16 v[200:201], v33 offset:25600
    v_mfma_f32_16x16x32_bf16 v[148:151], v[176:179], a[64:67], v[148:151]
    s_waitcnt lgkmcnt(7)
    ds_read_b64_tr_b16 v[202:203], v33 offset:27648
    v_mfma_f32_16x16x32_bf16 v[160:163], v[180:183], a[64:67], v[160:163]
    ds_read_b64_tr_b16 v[40:41], v9 offset:8192
    v_mfma_f32_16x16x32_bf16 v[168:171], v[180:183], a[68:71], v[168:171]
    ds_read_b64_tr_b16 v[42:43], v9 offset:10240
    v_mfma_f32_16x16x32_bf16 v[172:175], v[184:187], a[68:71], v[172:175]
    ds_read_b64_tr_b16 v[176:177], v30 offset:8192
    v_mfma_f32_16x16x32_bf16 v[164:167], v[184:187], a[64:67], v[164:167]
    s_waitcnt lgkmcnt(7)
    ds_read_b64_tr_b16 v[178:179], v30 offset:10240
    v_mfma_f32_16x16x32_bf16 v[144:147], v[188:191], a[72:75], v[144:147]
    ds_read_b64_tr_b16 v[180:181], v9 offset:9216
    v_mfma_f32_16x16x32_bf16 v[152:155], v[188:191], a[76:79], v[152:155]
    ds_read_b64_tr_b16 v[182:183], v9 offset:11264
    v_mfma_f32_16x16x32_bf16 v[156:159], v[192:195], a[76:79], v[156:159]
    ds_read_b64_tr_b16 v[184:185], v30 offset:9216
    v_mfma_f32_16x16x32_bf16 v[148:151], v[192:195], a[72:75], v[148:151]
    s_waitcnt lgkmcnt(7)
    ds_read_b64_tr_b16 v[186:187], v30 offset:11264
    s_waitcnt vmcnt(3)
    v_cmp_ne_u32 vcc, s78, v10
    s_nop 0
    s_or_b64 s[56:57], vcc, s[60:61]
    s_cbranch_scc1 L_poll_15
L_pollback_16:
    v_mfma_f32_16x16x32_bf16 v[160:163], v[196:199], a[72:75], v[160:163]
    s_mov_b32 s82, 262144
    ds_read_b64_tr_b16 v[188:189], v9 offset:20480
    buffer_load_dwordx4 a[128:131], v34, s[32:35], s82 offen offset:0 sc1
    v_mfma_f32_16x16x32_bf16 v[168:171], v[196:199], a[76:79], v[168:171]
    ds_read_b64_tr_b16 v[190:191], v9 offset:22528
    buffer_load_dwordx4 a[132:135], v38, s[32:35], s82 offen offset:0 sc1
    v_mfma_f32_16x16x32_bf16 v[172:175], v[200:203], a[76:79], v[172:175]
    ds_read_b64_tr_b16 v[192:193], v30 offset:20480
    v_mfma_f32_16x16x32_bf16 v[164:167], v[200:203], a[72:75], v[164:167]
    s_waitcnt lgkmcnt(7)
    ds_read_b64_tr_b16 v[194:195], v30 offset:22528
    s_barrier
    v_mfma_f32_16x16x32_bf16 v[144:147], v[40:43], a[80:83], v[144:147]
    ds_read_b64_tr_b16 v[196:197], v9 offset:21504
    v_mfma_f32_16x16x32_bf16 v[152:155], v[40:43], a[84:87], v[152:155]
    ds_read_b64_tr_b16 v[198:199], v9 offset:23552
    buffer_load_dwordx4 a[136:139], v34, s[32:35], s82 offen offset:2048 sc1
    v_mfma_f32_16x16x32_bf16 v[156:159], v[176:179], a[84:87], v[156:159]
    ds_read_b64_tr_b16 v[200:201], v30 offset:21504
    v_mfma_f32_16x16x32_bf16 v[148:151], v[176:179], a[80:83], v[148:151]
    s_waitcnt lgkmcnt(7)
    ds_read_b64_tr_b16 v[202:203], v30 offset:23552
    v_mfma_f32_16x16x32_bf16 v[160:163], v[180:183], a[80:83], v[160:163]
    ds_read_b64_tr_b16 v[40:41], v76 offset:8192
    buffer_load_dwordx4 a[140:143], v38, s[32:35], s82 offen offset:2048 sc1
    v_mfma_f32_16x16x32_bf16 v[168:171], v[180:183], a[84:87], v[168:171]
    s_mov_b32 s82, 266240
    ds_read_b64_tr_b16 v[42:43], v76 offset:10240
    buffer_load_dwordx4 a[144:147], v34, s[32:35], s82 offen offset:0 sc1
    v_mfma_f32_16x16x32_bf16 v[172:175], v[184:187], a[84:87], v[172:175]
    ds_read_b64_tr_b16 v[176:177], v8 offset:8192
    v_mfma_f32_16x16x32_bf16 v[164:167], v[184:187], a[80:83], v[164:167]
    s_waitcnt lgkmcnt(7)
    ds_read_b64_tr_b16 v[178:179], v8 offset:10240
    v_mfma_f32_16x16x32_bf16 v[144:147], v[188:191], a[88:91], v[144:147]
    ds_read_b64_tr_b16 v[180:181], v76 offset:9216
    v_mfma_f32_16x16x32_bf16 v[152:155], v[188:191], a[92:95], v[152:155]
    ds_read_b64_tr_b16 v[182:183], v76 offset:11264
    buffer_load_dwordx4 a[148:151], v38, s[32:35], s82 offen offset:0 sc1
    v_mfma_f32_16x16x32_bf16 v[156:159], v[192:195], a[92:95], v[156:159]
    ds_read_b64_tr_b16 v[184:185], v8 offset:9216
    v_mfma_f32_16x16x32_bf16 v[148:151], v[192:195], a[88:91], v[148:151]
    s_waitcnt lgkmcnt(7)
    ds_read_b64_tr_b16 v[186:187], v8 offset:11264
    v_mfma_f32_16x16x32_bf16 v[160:163], v[196:199], a[88:91], v[160:163]
    ds_read_b64_tr_b16 v[188:189], v76 offset:20480
    buffer_load_dwordx4 a[152:155], v34, s[32:35], s82 offen offset:2048 sc1
    v_mfma_f32_16x16x32_bf16 v[168:171], v[196:199], a[92:95], v[168:171]
    ds_read_b64_tr_b16 v[190:191], v76 offset:22528
    buffer_load_dwordx4 a[156:159], v38, s[32:35], s82 offen offset:2048 sc1
    v_mfma_f32_16x16x32_bf16 v[172:175], v[200:203], a[92:95], v[172:175]
    ds_read_b64_tr_b16 v[192:193], v8 offset:20480
    v_mfma_f32_16x16x32_bf16 v[164:167], v[200:203], a[88:91], v[164:167]
    s_waitcnt lgkmcnt(7)
    ds_read_b64_tr_b16 v[194:195], v8 offset:22528
    v_mfma_f32_16x16x32_bf16 v[144:147], v[40:43], a[96:99], v[144:147]
    ds_read_b64_tr_b16 v[196:197], v76 offset:21504
    v_mfma_f32_16x16x32_bf16 v[152:155], v[40:43], a[100:103], v[152:155]
    s_mov_b32 s82, 270336
    ds_read_b64_tr_b16 v[198:199], v76 offset:23552
    buffer_load_dwordx4 a[160:163], v34, s[32:35], s82 offen offset:0 sc1
    v_mfma_f32_16x16x32_bf16 v[156:159], v[176:179], a[100:103], v[156:159]
    ds_read_b64_tr_b16 v[200:201], v8 offset:21504
    v_mfma_f32_16x16x32_bf16 v[148:151], v[176:179], a[96:99], v[148:151]
    s_waitcnt lgkmcnt(7)
    ds_read_b64_tr_b16 v[202:203], v8 offset:23552
    v_mfma_f32_16x16x32_bf16 v[160:163], v[180:183], a[96:99], v[160:163]
    ds_read_b64_tr_b16 v[40:41], v9 offset:36864
    buffer_load_dwordx4 a[164:167], v38, s[32:35], s82 offen offset:0 sc1
    v_mfma_f32_16x16x32_bf16 v[168:171], v[180:183], a[100:103], v[168:171]
    ds_read_b64_tr_b16 v[42:43], v9 offset:38912
    buffer_load_dwordx4 a[168:171], v34, s[32:35], s82 offen offset:2048 sc1
    v_mfma_f32_16x16x32_bf16 v[172:175], v[184:187], a[100:103], v[172:175]
    ds_read_b64_tr_b16 v[176:177], v30 offset:36864
    v_mfma_f32_16x16x32_bf16 v[164:167], v[184:187], a[96:99], v[164:167]
    s_waitcnt lgkmcnt(7)
    ds_read_b64_tr_b16 v[178:179], v30 offset:38912
    s_waitcnt vmcnt(11)
    s_cmp_lg_u32 s60, 0
    s_cbranch_scc1 L_slowsig_17
    s_mov_b64 exec, 8
    buffer_store_dword v74, v69, s[32:35], 0 offen
    s_mov_b64 exec, -1
L_sigback_18:
    v_mfma_f32_16x16x32_bf16 v[144:147], v[188:191], a[104:107], v[144:147]
    ds_read_b64_tr_b16 v[180:181], v9 offset:37888
    v_mfma_f32_16x16x32_bf16 v[152:155], v[188:191], a[108:111], v[152:155]
    ds_read_b64_tr_b16 v[182:183], v9 offset:39936
    buffer_load_dwordx4 a[172:175], v38, s[32:35], s82 offen offset:2048 sc1
    v_mfma_f32_16x16x32_bf16 v[156:159], v[192:195], a[108:111], v[156:159]
    ds_read_b64_tr_b16 v[184:185], v30 offset:37888
    v_mfma_f32_16x16x32_bf16 v[148:151], v[192:195], a[104:107], v[148:151]
    s_waitcnt lgkmcnt(7)
    ds_read_b64_tr_b16 v[186:187], v30 offset:39936
    v_mfma_f32_16x16x32_bf16 v[160:163], v[196:199], a[104:107], v[160:163]
    s_mov_b32 s82, 274432
    ds_read_b64_tr_b16 v[188:189], v9 offset:49152
    buffer_load_dwordx4 a[176:179], v34, s[32:35], s82 offen offset:0 sc1
    v_mfma_f32_16x16x32_bf16 v[168:171], v[196:199], a[108:111], v[168:171]
    ds_read_b64_tr_b16 v[190:191], v9 offset:51200
    buffer_load_dwordx4 a[180:183], v38, s[32:35], s82 offen offset:0 sc1
    v_mfma_f32_16x16x32_bf16 v[172:175], v[200:203], a[108:111], v[172:175]
    ds_read_b64_tr_b16 v[192:193], v30 offset:49152
    v_mfma_f32_16x16x32_bf16 v[164:167], v[200:203], a[104:107], v[164:167]
    s_waitcnt lgkmcnt(7)
    ds_read_b64_tr_b16 v[194:195], v30 offset:51200
    v_mfma_f32_16x16x32_bf16 v[144:147], v[40:43], a[112:115], v[144:147]
    ds_read_b64_tr_b16 v[196:197], v9 offset:50176
    v_mfma_f32_16x16x32_bf16 v[152:155], v[40:43], a[116:119], v[152:155]
    ds_read_b64_tr_b16 v[198:199], v9 offset:52224
    buffer_load_dwordx4 a[184:187], v39, s[32:35], s82 offen offset:2048 sc1
    v_mfma_f32_16x16x32_bf16 v[156:159], v[176:179], a[116:119], v[156:159]
L_warm_5:
    s_cbranch_execz L_warm_back
    ds_read_b64_tr_b16 v[200:201], v30 offset:50176
    v_mfma_f32_16x16x32_bf16 v[148:151], v[176:179], a[112:115], v[148:151]
    s_waitcnt lgkmcnt(7)
    ds_read_b64_tr_b16 v[202:203], v30 offset:52224
    v_mfma_f32_16x16x32_bf16 v[160:163], v[180:183], a[112:115], v[160:163]
    ds_read_b64_tr_b16 v[40:41], v16 offset:53248
    buffer_load_dwordx4 a[188:191], v50, s[32:35], s82 offen offset:2048 sc1
    v_mfma_f32_16x16x32_bf16 v[168:171], v[180:183], a[116:119], v[168:171]
    s_add_u32 m0, s66, 16384
    s_mov_b32 s77, 1212416
    ds_read_b64_tr_b16 v[42:43], v16 offset:57344
    buffer_load_dwordx4 v45, s[20:23], s77 offen lds
    v_mfma_f32_16x16x32_bf16 v[172:175], v[184:187], a[116:119], v[172:175]
    ds_read_b64_tr_b16 v[176:177], v19 offset:53248
    v_mfma_f32_16x16x32_bf16 v[164:167], v[184:187], a[112:115], v[164:167]
    s_waitcnt lgkmcnt(7)
    ds_read_b64_tr_b16 v[178:179], v19 offset:57344
    v_mfma_f32_16x16x32_bf16 v[144:147], v[188:191], a[120:123], v[144:147]
    s_mov_b32 s77, 1228800
    ds_read_b64_tr_b16 v[180:181], v25 offset:53248
    v_mfma_f32_16x16x32_bf16 v[152:155], v[188:191], a[124:127], v[152:155]
    s_add_u32 m0, s66, 98304
    ds_read_b64_tr_b16 v[182:183], v25 offset:57344
    buffer_load_dwordx4 v45, s[20:23], s77 offen lds
    v_mfma_f32_16x16x32_bf16 v[156:159], v[192:195], a[124:127], v[156:159]
    ds_read_b64_tr_b16 v[184:185], v27 offset:53248
    v_mfma_f32_16x16x32_bf16 v[148:151], v[192:195], a[120:123], v[148:151]
    s_waitcnt lgkmcnt(7)
    ds_read_b64_tr_b16 v[186:187], v27 offset:57344
    v_mfma_f32_16x16x32_bf16 v[160:163], v[196:199], a[120:123], v[160:163]
    s_add_u32 m0, s66, 110592
    s_mov_b32 s77, 65536
    ds_read_b64_tr_b16 v[188:189], v16 offset:61440
    buffer_load_dwordx4 v45, s[20:23], s77 offen lds
    v_mfma_f32_16x16x32_bf16 v[168:171], v[196:199], a[124:127], v[168:171]
    s_add_u32 m0, s66, 131072
    s_mov_b32 s77, 81920
    ds_read_b64_tr_b16 v[190:191], v75 offset:45056
    buffer_load_dwordx4 v45, s[20:23], s77 offen lds
    v_mfma_f32_16x16x32_bf16 v[172:175], v[200:203], a[124:127], v[172:175]
    ds_read_b64_tr_b16 v[192:193], v19 offset:61440
    v_mfma_f32_16x16x32_bf16 v[164:167], v[200:203], a[120:123], v[164:167]
    ds_read_b64_tr_b16 v[194:195], v13 offset:45056
    v_pk_mul_f32 v[228:229], v[144:145], v[144:145]
    v_pk_mul_f32 v[230:231], v[146:147], v[146:147]
    v_pk_fma_f32 v[228:229], v[228:229], v[224:225], v[78:79] op_sel:[0,0,0] op_sel_hi:[1,0,0]
    v_pk_fma_f32 v[230:231], v[230:231], v[224:225], v[78:79] op_sel:[0,0,0] op_sel_hi:[1,0,0]
    v_pk_mul_f32 v[228:229], v[228:229], v[144:145]
    v_pk_mul_f32 v[230:231], v[230:231], v[146:147]
    v_exp_f32 v228, v228
    v_exp_f32 v229, v229
    v_exp_f32 v230, v230
    v_exp_f32 v231, v231
    v_pk_mul_f32 v[160:161], v[160:161], v[144:145]
    v_pk_mul_f32 v[162:163], v[162:163], v[146:147]
    v_pk_fma_f32 v[228:229], v[228:229], v[226:227], v[226:227] op_sel:[0,0,0] op_sel_hi:[1,0,0]
    v_pk_fma_f32 v[230:231], v[230:231], v[226:227], v[226:227] op_sel:[0,0,0] op_sel_hi:[1,0,0]
    v_rcp_f32 v228, v228
    v_rcp_f32 v229, v229
    v_rcp_f32 v230, v230
    v_rcp_f32 v231, v231
    v_pk_mul_f32 v[160:161], v[160:161], v[228:229]
    v_pk_mul_f32 v[162:163], v[162:163], v[230:231]
    v_cvt_pk_bf16_f32 v236, v160, v161
    v_cvt_pk_bf16_f32 v237, v162, v163
    v_pk_mul_f32 v[232:233], v[148:149], v[148:149]
    v_pk_mul_f32 v[234:235], v[150:151], v[150:151]
    s_add_u32 m0, s66, 143360
    s_mov_b32 s77, 262144
    buffer_load_dwordx4 v45, s[20:23], s77 offen lds
    v_pk_fma_f32 v[232:233], v[232:233], v[224:225], v[78:79] op_sel:[0,0,0] op_sel_hi:[1,0,0]
    v_pk_fma_f32 v[234:235], v[234:235], v[224:225], v[78:79] op_sel:[0,0,0] op_sel_hi:[1,0,0]
    v_pk_mul_f32 v[232:233], v[232:233], v[148:149]
    v_pk_mul_f32 v[234:235], v[234:235], v[150:151]
    v_exp_f32 v232, v232
    v_exp_f32 v233, v233
    v_exp_f32 v234, v234
    v_exp_f32 v235, v235
    v_pk_mul_f32 v[164:165], v[164:165], v[148:149]
    v_pk_mul_f32 v[166:167], v[166:167], v[150:151]
    v_pk_fma_f32 v[232:233], v[232:233], v[226:227], v[226:227] op_sel:[0,0,0] op_sel_hi:[1,0,0]
    v_pk_fma_f32 v[234:235], v[234:235], v[226:227], v[226:227] op_sel:[0,0,0] op_sel_hi:[1,0,0]
    v_rcp_f32 v232, v232
    v_rcp_f32 v233, v233
    v_rcp_f32 v234, v234
    v_rcp_f32 v235, v235
    v_pk_mul_f32 v[164:165], v[164:165], v[232:233]
    v_pk_mul_f32 v[166:167], v[166:167], v[234:235]
    v_cvt_pk_bf16_f32 v238, v164, v165
    v_cvt_pk_bf16_f32 v239, v166, v167
    s_add_u32 s73, s91, 131072
    buffer_store_dwordx4 v[236:239], v17, s[32:35], s73 offen
    v_pk_mul_f32 v[228:229], v[152:153], v[152:153]
    v_pk_mul_f32 v[230:231], v[154:155], v[154:155]
    v_pk_fma_f32 v[228:229], v[228:229], v[224:225], v[78:79] op_sel:[0,1,1] op_sel_hi:[1,1,1]
    v_pk_fma_f32 v[230:231], v[230:231], v[224:225], v[78:79] op_sel:[0,1,1] op_sel_hi:[1,1,1]
    v_pk_mul_f32 v[228:229], v[228:229], v[152:153]
    v_pk_mul_f32 v[230:231], v[230:231], v[154:155]
    v_exp_f32 v228, v228
    v_exp_f32 v229, v229
    v_exp_f32 v230, v230
    v_exp_f32 v231, v231
    v_pk_mul_f32 v[168:169], v[168:169], v[152:153]
    v_pk_mul_f32 v[170:171], v[170:171], v[154:155]
    s_add_u32 m0, s66, 155648
    s_mov_b32 s77, 278528
    buffer_load_dwordx4 v45, s[20:23], s77 offen lds
    v_pk_fma_f32 v[228:229], v[228:229], v[226:227], v[226:227] op_sel:[0,1,1] op_sel_hi:[1,1,1]
    v_pk_fma_f32 v[230:231], v[230:231], v[226:227], v[226:227] op_sel:[0,1,1] op_sel_hi:[1,1,1]
    v_rcp_f32 v228, v228
    v_rcp_f32 v229, v229
    v_rcp_f32 v230, v230
    v_rcp_f32 v231, v231
    v_pk_mul_f32 v[168:169], v[168:169], v[228:229]
    v_pk_mul_f32 v[170:171], v[170:171], v[230:231]
    v_cvt_pk_bf16_f32 v240, v168, v169
    v_cvt_pk_bf16_f32 v241, v170, v171
    v_pk_mul_f32 v[232:233], v[156:157], v[156:157]
    v_pk_mul_f32 v[234:235], v[158:159], v[158:159]
    v_pk_fma_f32 v[232:233], v[232:233], v[224:225], v[78:79] op_sel:[0,1,1] op_sel_hi:[1,1,1]
    v_pk_fma_f32 v[234:235], v[234:235], v[224:225], v[78:79] op_sel:[0,1,1] op_sel_hi:[1,1,1]
    v_pk_mul_f32 v[232:233], v[232:233], v[156:157]
    v_pk_mul_f32 v[234:235], v[234:235], v[158:159]
    v_exp_f32 v232, v232
    v_exp_f32 v233, v233
    v_exp_f32 v234, v234
    v_exp_f32 v235, v235
    v_pk_mul_f32 v[172:173], v[172:173], v[156:157]
    v_pk_mul_f32 v[174:175], v[174:175], v[158:159]
    v_pk_fma_f32 v[232:233], v[232:233], v[226:227], v[226:227] op_sel:[0,1,1] op_sel_hi:[1,1,1]
    v_pk_fma_f32 v[234:235], v[234:235], v[226:227], v[226:227] op_sel:[0,1,1] op_sel_hi:[1,1,1]
    v_rcp_f32 v232, v232
    v_rcp_f32 v233, v233
    v_rcp_f32 v234, v234
    v_rcp_f32 v235, v235
    v_pk_mul_f32 v[172:173], v[172:173], v[232:233]
    v_pk_mul_f32 v[174:175], v[174:175], v[234:235]
    v_cvt_pk_bf16_f32 v242, v172, v173
    v_cvt_pk_bf16_f32 v243, v174, v175
    s_add_u32 s73, s91, 147456
    buffer_store_dwordx4 v[240:243], v17, s[32:35], s73 offen
    s_waitcnt vmcnt(23) lgkmcnt(8)
    s_barrier
    v_mfma_f32_16x16x32_bf16 v[52:55], v[40:43], a[128:131], v[52:55]
    ds_read_b64_tr_b16 v[196:197], v25 offset:61440
    v_mfma_f32_16x16x32_bf16 v[204:207], v[40:43], a[132:135], 0
    ds_read_b64_tr_b16 v[198:199], v14 offset:45056
    buffer_load_dword v10, v73, s[32:35], 0 offen offset:1536 sc1
    v_mfma_f32_16x16x32_bf16 v[208:211], v[176:179], a[132:135], 0
    ds_read_b64_tr_b16 v[200:201], v27 offset:61440
    v_mfma_f32_16x16x32_bf16 v[56:59], v[176:179], a[128:131], v[56:59]
    s_waitcnt lgkmcnt(7)
    ds_read_b64_tr_b16 v[202:203], v15 offset:45056
    v_mfma_f32_16x16x32_bf16 v[60:63], v[180:183], a[128:131], v[60:63]
    s_mov_b32 s77, 458752
    ds_read_b64_tr_b16 v[40:41], v75 offset:49152
    v_mfma_f32_16x16x32_bf16 v[212:215], v[180:183], a[132:135], 0
    s_add_u32 m0, s66, 73728
    ds_read_b64_tr_b16 v[42:43], v75 offset:53248
    buffer_load_dwordx4 v45, s[20:23], s77 offen lds
    v_mfma_f32_16x16x32_bf16 v[216:219], v[184:187], a[132:135], 0
    ds_read_b64_tr_b16 v[176:177], v13 offset:49152
    v_mfma_f32_16x16x32_bf16 v[64:67], v[184:187], a[128:131], v[64:67]
    s_waitcnt vmcnt(23) lgkmcnt(7)
    ds_read_b64_tr_b16 v[178:179], v13 offset:53248
    v_mfma_f32_16x16x32_bf16 v[52:55], v[188:191], a[136:139], v[52:55]
    s_mov_b32 s77, 475136
    ds_read_b64_tr_b16 v[180:181], v14 offset:49152
    v_mfma_f32_16x16x32_bf16 v[204:207], v[188:191], a[140:143], v[204:207]
    s_add_u32 m0, s66, 86016
    ds_read_b64_tr_b16 v[182:183], v14 offset:53248
    buffer_load_dwordx4 v45, s[20:23], s77 offen lds
    v_mfma_f32_16x16x32_bf16 v[208:211], v[192:195], a[140:143], v[208:211]
    ds_read_b64_tr_b16 v[184:185], v15 offset:49152
    v_mfma_f32_16x16x32_bf16 v[56:59], v[192:195], a[136:139], v[56:59]
    s_waitcnt lgkmcnt(7)
    ds_read_b64_tr_b16 v[186:187], v15 offset:53248
    v_mfma_f32_16x16x32_bf16 v[60:63], v[196:199], a[136:139], v[60:63]
    s_add_u32 m0, s66, 8192
    s_mov_b32 s77, 655360
    ds_read_b64_tr_b16 v[188:189], v75 offset:24576
    buffer_load_dwordx4 v45, s[20:23], s77 offen lds
    v_mfma_f32_16x16x32_bf16 v[212:215], v[196:199], a[140:143], v[212:215]
    s_add_u32 m0, s66, 20480
    s_mov_b32 s77, 671744
    ds_read_b64_tr_b16 v[190:191], v75 offset:28672
    buffer_load_dwordx4 v45, s[20:23], s77 offen lds
    v_mfma_f32_16x16x32_bf16 v[216:219], v[200:203], a[140:143], v[216:219]
    ds_read_b64_tr_b16 v[192:193], v13 offset:24576
    v_mfma_f32_16x16x32_bf16 v[64:67], v[200:203], a[136:139], v[64:67]
    s_waitcnt vmcnt(24) lgkmcnt(7)
    ds_read_b64_tr_b16 v[194:195], v13 offset:28672
    s_waitcnt vmcnt(10)
    s_barrier
    v_mfma_f32_16x16x32_bf16 v[52:55], v[40:43], a[144:147], v[52:55]
    s_mov_b32 s77, 851968
    ds_read_b64_tr_b16 v[196:197], v14 offset:24576
    v_mfma_f32_16x16x32_bf16 v[204:207], v[40:43], a[148:151], v[204:207]
    s_add_u32 m0, s66, 102400
    ds_read_b64_tr_b16 v[198:199], v14 offset:28672
    buffer_load_dwordx4 v45, s[20:23], s77 offen lds
    v_mfma_f32_16x16x32_bf16 v[208:211], v[176:179], a[148:151], v[208:211]
    ds_read_b64_tr_b16 v[200:201], v15 offset:24576
    v_mfma_f32_16x16x32_bf16 v[56:59], v[176:179], a[144:147], v[56:59]
    s_waitcnt lgkmcnt(7)
    ds_read_b64_tr_b16 v[202:203], v15 offset:28672
    v_mfma_f32_16x16x32_bf16 v[60:63], v[180:183], a[144:147], v[60:63]
    s_mov_b32 s77, 868352
    ds_read_b64_tr_b16 v[40:41], v75 offset:32768
    v_mfma_f32_16x16x32_bf16 v[212:215], v[180:183], a[148:151], v[212:215]
    s_add_u32 m0, s66, 114688
    ds_read_b64_tr_b16 v[42:43], v75 offset:0
    buffer_load_dwordx4 v45, s[20:23], s77 offen lds
    v_mfma_f32_16x16x32_bf16 v[216:219], v[184:187], a[148:151], v[216:219]
    ds_read_b64_tr_b16 v[176:177], v13 offset:32768
    v_mfma_f32_16x16x32_bf16 v[64:67], v[184:187], a[144:147], v[64:67]
    s_waitcnt lgkmcnt(7)
    ds_read_b64_tr_b16 v[178:179], v13 offset:0
    v_mfma_f32_16x16x32_bf16 v[52:55], v[188:191], a[152:155], v[52:55]
    s_mov_b32 s77, 1048576
    ds_read_b64_tr_b16 v[180:181], v14 offset:32768
    v_mfma_f32_16x16x32_bf16 v[204:207], v[188:191], a[156:159], v[204:207]
    s_add_u32 m0, s66, 118784
    ds_read_b64_tr_b16 v[182:183], v14 offset:0
    buffer_load_dwordx4 v45, s[20:23], s77 offen lds
    v_mfma_f32_16x16x32_bf16 v[208:211], v[192:195], a[156:159], v[208:211]
    ds_read_b64_tr_b16 v[184:185], v15 offset:32768
    v_mfma_f32_16x16x32_bf16 v[56:59], v[192:195], a[152:155], v[56:59]
    s_waitcnt lgkmcnt(7)
    ds_read_b64_tr_b16 v[186:187], v15 offset:0
    s_waitcnt vmcnt(7)
    v_cmp_ne_u32 vcc, s78, v10
    s_nop 0
    s_or_b64 s[56:57], vcc, s[60:61]
    s_cbranch_scc1 L_poll_19
L_pollback_20:
    s_cmp_lg_u32 s60, 0
    s_cbranch_scc1 L_slowsig_21
    s_mov_b64 exec, 16
    buffer_store_dword v74, v69, s[32:35], 0 offen
    s_mov_b64 exec, -1
L_sigback_22:
    v_mfma_f32_16x16x32_bf16 v[60:63], v[196:199], a[152:155], v[60:63]
    s_mov_b32 s82, 393216
    ds_read_b64_tr_b16 v[188:189], v75 offset:36864
    buffer_load_dwordx4 a[192:195], v34, s[32:35], s82 offen offset:0 sc1
    v_mfma_f32_16x16x32_bf16 v[212:215], v[196:199], a[156:159], v[212:215]
    ds_read_b64_tr_b16 v[190:191], v75 offset:40960
    buffer_load_dwordx4 a[196:199], v38, s[32:35], s82 offen offset:0 sc1
    v_mfma_f32_16x16x32_bf16 v[216:219], v[200:203], a[156:159], v[216:219]
    ds_read_b64_tr_b16 v[192:193], v13 offset:36864
    v_mfma_f32_16x16x32_bf16 v[64:67], v[200:203], a[152:155], v[64:67]
    s_waitcnt lgkmcnt(7)
    ds_read_b64_tr_b16 v[194:195], v13 offset:40960
    v_mfma_f32_16x16x32_bf16 v[52:55], v[40:43], a[160:163], v[52:55]
    s_mov_b32 s77, 1064960
    ds_read_b64_tr_b16 v[196:197], v14 offset:36864
    v_mfma_f32_16x16x32_bf16 v[204:207], v[40:43], a[164:167], v[204:207]
    s_add_u32 m0, s66, 122880
    ds_read_b64_tr_b16 v[198:199], v14 offset:40960
    buffer_load_dwordx4 v45, s[20:23], s77 offen lds
    v_mfma_f32_16x16x32_bf16 v[208:211], v[176:179], a[164:167], v[208:211]
    ds_read_b64_tr_b16 v[200:201], v15 offset:36864
    v_mfma_f32_16x16x32_bf16 v[56:59], v[176:179], a[160:163], v[56:59]
    s_waitcnt lgkmcnt(7)
    ds_read_b64_tr_b16 v[202:203], v15 offset:40960
    v_mfma_f32_16x16x32_bf16 v[60:63], v[180:183], a[160:163], v[60:63]
    s_mov_b32 s77, 1245184
    ds_read_b64_tr_b16 v[40:41], v75 offset:57344
    v_mfma_f32_16x16x32_bf16 v[212:215], v[180:183], a[164:167], v[212:215]
    s_add_u32 m0, s66, 126976
    ds_read_b64_tr_b16 v[42:43], v75 offset:61440
    buffer_load_dwordx4 v45, s[20:23], s77 offen lds
    v_mfma_f32_16x16x32_bf16 v[216:219], v[184:187], a[164:167], v[216:219]
    ds_read_b64_tr_b16 v[176:177], v13 offset:57344
    v_mfma_f32_16x16x32_bf16 v[64:67], v[184:187], a[160:163], v[64:67]
    s_waitcnt lgkmcnt(7)
    ds_read_b64_tr_b16 v[178:179], v13 offset:61440
    v_mfma_f32_16x16x32_bf16 v[52:55], v[188:191], a[168:171], v[52:55]
    s_mov_b32 s77, 1261568
    ds_read_b64_tr_b16 v[180:181], v14 offset:57344
    v_mfma_f32_16x16x32_bf16 v[204:207], v[188:191], a[172:175], v[204:207]
    s_add_u32 m0, s66, 45056
    ds_read_b64_tr_b16 v[182:183], v14 offset:61440
    buffer_load_dwordx4 v45, s[20:23], s77 offen lds
    v_mfma_f32_16x16x32_bf16 v[208:211], v[192:195], a[172:175], v[208:211]
    ds_read_b64_tr_b16 v[184:185], v15 offset:57344
    v_mfma_f32_16x16x32_bf16 v[56:59], v[192:195], a[168:171], v[56:59]
    s_waitcnt lgkmcnt(7)
    ds_read_b64_tr_b16 v[186:187], v15 offset:61440
    v_mfma_f32_16x16x32_bf16 v[60:63], v[196:199], a[168:171], v[60:63]
    ds_read_b64_tr_b16 v[188:189], v18 offset:4096
    buffer_load_dwordx4 a[200:203], v34, s[32:35], s82 offen offset:2048 sc1
    v_mfma_f32_16x16x32_bf16 v[212:215], v[196:199], a[172:175], v[212:215]
    ds_read_b64_tr_b16 v[190:191], v18 offset:16384
    buffer_load_dwordx4 a[204:207], v38, s[32:35], s82 offen offset:2048 sc1
    v_mfma_f32_16x16x32_bf16 v[216:219], v[200:203], a[172:175], v[216:219]
    ds_read_b64_tr_b16 v[192:193], v24 offset:4096
    v_mfma_f32_16x16x32_bf16 v[64:67], v[200:203], a[168:171], v[64:67]
    s_waitcnt lgkmcnt(7)
    ds_read_b64_tr_b16 v[194:195], v24 offset:16384
    v_mfma_f32_16x16x32_bf16 v[52:55], v[40:43], a[176:179], v[52:55]
    ds_read_b64_tr_b16 v[196:197], v26 offset:4096
    v_mfma_f32_16x16x32_bf16 v[204:207], v[40:43], a[180:183], v[204:207]
    s_mov_b32 s82, 397312
    ds_read_b64_tr_b16 v[198:199], v26 offset:16384
    buffer_load_dwordx4 a[208:211], v34, s[32:35], s82 offen offset:0 sc1
    v_mfma_f32_16x16x32_bf16 v[208:211], v[176:179], a[180:183], v[208:211]
    ds_read_b64_tr_b16 v[200:201], v28 offset:4096
    v_mfma_f32_16x16x32_bf16 v[56:59], v[176:179], a[176:179], v[56:59]
    s_waitcnt lgkmcnt(7)
    ds_read_b64_tr_b16 v[202:203], v28 offset:16384
    v_mfma_f32_16x16x32_bf16 v[60:63], v[180:183], a[176:179], v[60:63]
    ds_read_b64_tr_b16 v[40:41], v18 offset:28672
    v_mfma_f32_16x16x32_bf16 v[212:215], v[180:183], a[180:183], v[212:215]
    ds_read_b64_tr_b16 v[42:43], v16 offset:12288
    buffer_load_dwordx4 a[212:215], v38, s[32:35], s82 offen offset:0 sc1
    v_mfma_f32_16x16x32_bf16 v[216:219], v[184:187], a[180:183], v[216:219]
    ds_read_b64_tr_b16 v[176:177], v24 offset:28672
    v_mfma_f32_16x16x32_bf16 v[64:67], v[184:187], a[176:179], v[64:67]
    s_waitcnt lgkmcnt(7)
    ds_read_b64_tr_b16 v[178:179], v19 offset:12288
    v_mfma_f32_16x16x32_bf16 v[52:55], v[188:191], a[184:187], v[52:55]
    ds_read_b64_tr_b16 v[180:181], v26 offset:28672
    v_mfma_f32_16x16x32_bf16 v[204:207], v[188:191], a[188:191], v[204:207]
    ds_read_b64_tr_b16 v[182:183], v25 offset:12288
    buffer_load_dwordx4 a[216:219], v34, s[32:35], s82 offen offset:2048 sc1
    v_mfma_f32_16x16x32_bf16 v[208:211], v[192:195], a[188:191], v[208:211]
    ds_read_b64_tr_b16 v[184:185], v28 offset:28672
    v_mfma_f32_16x16x32_bf16 v[56:59], v[192:195], a[184:187], v[56:59]
    s_waitcnt lgkmcnt(7)
    ds_read_b64_tr_b16 v[186:187], v27 offset:12288
    v_mfma_f32_16x16x32_bf16 v[60:63], v[196:199], a[184:187], v[60:63]
    ds_read_b64_tr_b16 v[188:189], v16 offset:24576
    buffer_load_dword v10, v73, s[32:35], 0 offen offset:2048 sc1
    v_mfma_f32_16x16x32_bf16 v[212:215], v[196:199], a[188:191], v[212:215]
    ds_read_b64_tr_b16 v[190:191], v75 offset:12288
    buffer_load_dwordx4 a[220:223], v38, s[32:35], s82 offen offset:2048 sc1
    v_mfma_f32_16x16x32_bf16 v[216:219], v[200:203], a[188:191], v[216:219]
    ds_read_b64_tr_b16 v[192:193], v19 offset:24576
    v_mfma_f32_16x16x32_bf16 v[64:67], v[200:203], a[184:187], v[64:67]
    s_waitcnt vmcnt(10) lgkmcnt(7)
    ds_read_b64_tr_b16 v[194:195], v13 offset:12288
    v_mfma_f32_16x16x32_bf16 v[52:55], v[40:43], a[192:195], v[52:55]
    ds_read_b64_tr_b16 v[196:197], v25 offset:24576
    v_mfma_f32_16x16x32_bf16 v[204:207], v[40:43], a[196:199], v[204:207]
    s_mov_b32 s82, 401408
    ds_read_b64_tr_b16 v[198:199], v14 offset:12288
    buffer_load_dwordx4 a[224:227], v34, s[32:35], s82 offen offset:0 sc1
    v_mfma_f32_16x16x32_bf16 v[208:211], v[176:179], a[196:199], v[208:211]
    ds_read_b64_tr_b16 v[200:201], v27 offset:24576
    v_mfma_f32_16x16x32_bf16 v[56:59], v[176:179], a[192:195], v[56:59]
    s_waitcnt lgkmcnt(7)
    ds_read_b64_tr_b16 v[202:203], v15 offset:12288
    v_mfma_f32_16x16x32_bf16 v[60:63], v[180:183], a[192:195], v[60:63]
    ds_read_b64_tr_b16 v[40:41], v16 offset:28672
    v_mfma_f32_16x16x32_bf16 v[212:215], v[180:183], a[196:199], v[212:215]
    ds_read_b64_tr_b16 v[42:43], v16 offset:40960
    buffer_load_dwordx4 a[228:231], v38, s[32:35], s82 offen offset:0 sc1
    v_mfma_f32_16x16x32_bf16 v[216:219], v[184:187], a[196:199], v[216:219]
    ds_read_b64_tr_b16 v[176:177], v19 offset:28672
    v_mfma_f32_16x16x32_bf16 v[64:67], v[184:187], a[192:195], v[64:67]
    s_waitcnt vmcnt(7) lgkmcnt(7)
    ds_read_b64_tr_b16 v[178:179], v19 offset:40960
    v_mfma_f32_16x16x32_bf16 v[52:55], v[188:191], a[200:203], v[52:55]
    ds_read_b64_tr_b16 v[180:181], v25 offset:28672
    v_mfma_f32_16x16x32_bf16 v[204:207], v[188:191], a[204:207], v[204:207]
    ds_read_b64_tr_b16 v[182:183], v25 offset:40960
    buffer_load_dwordx4 a[232:235], v34, s[32:35], s82 offen offset:2048 sc1
    v_mfma_f32_16x16x32_bf16 v[208:211], v[192:195], a[204:207], v[208:211]
    ds_read_b64_tr_b16 v[184:185], v27 offset:28672
    v_mfma_f32_16x16x32_bf16 v[56:59], v[192:195], a[200:203], v[56:59]
    s_waitcnt lgkmcnt(7)
    ds_read_b64_tr_b16 v[186:187], v27 offset:40960
    v_mfma_f32_16x16x32_bf16 v[60:63], v[196:199], a[200:203], v[60:63]
    ds_read_b64_tr_b16 v[188:189], v16 offset:0
    buffer_load_dwordx4 a[236:239], v38, s[32:35], s82 offen offset:2048 sc1
    v_mfma_f32_16x16x32_bf16 v[212:215], v[196:199], a[204:207], v[212:215]
    s_mov_b32 s82, 405504
    ds_read_b64_tr_b16 v[190:191], v18 offset:8192
    buffer_load_dwordx4 a[240:243], v34, s[32:35], s82 offen offset:0 sc1
    v_mfma_f32_16x16x32_bf16 v[216:219], v[200:203], a[204:207], v[216:219]
    ds_read_b64_tr_b16 v[192:193], v19 offset:0
    v_mfma_f32_16x16x32_bf16 v[64:67], v[200:203], a[200:203], v[64:67]
    s_waitcnt vmcnt(8) lgkmcnt(7)
    ds_read_b64_tr_b16 v[194:195], v24 offset:8192
    s_barrier
    v_mfma_f32_16x16x32_bf16 v[52:55], v[40:43], a[208:211], v[52:55]
    ds_read_b64_tr_b16 v[196:197], v25 offset:0
    v_mfma_f32_16x16x32_bf16 v[204:207], v[40:43], a[212:215], v[204:207]
    ds_read_b64_tr_b16 v[198:199], v26 offset:8192
    buffer_load_dwordx4 a[244:247], v38, s[32:35], s82 offen offset:0 sc1
    v_mfma_f32_16x16x32_bf16 v[208:211], v[176:179], a[212:215], v[208:211]
    ds_read_b64_tr_b16 v[200:201], v27 offset:0
    v_mfma_f32_16x16x32_bf16 v[56:59], v[176:179], a[208:211], v[56:59]
    s_waitcnt lgkmcnt(7)
    ds_read_b64_tr_b16 v[202:203], v28 offset:8192
    s_waitcnt vmcnt(7)
    v_cmp_ne_u32 vcc, s78, v10
    s_nop 0
    s_or_b64 s[56:57], vcc, s[60:61]
    s_cbranch_scc1 L_poll_23
L_pollback_24:
    v_mfma_f32_16x16x32_bf16 v[60:63], v[180:183], a[208:211], v[60:63]
    ds_read_b64_tr_b16 v[40:41], v18 offset:20480
    v_mfma_f32_16x16x32_bf16 v[212:215], v[180:183], a[212:215], v[212:215]
    s_mov_b32 s82, 131072
    ds_read_b64_tr_b16 v[42:43], v16 offset:4096
    buffer_load_dwordx4 a[248:251], v34, s[32:35], s82 offen offset:0 sc1
    v_mfma_f32_16x16x32_bf16 v[216:219], v[184:187], a[212:215], v[216:219]
    ds_read_b64_tr_b16 v[176:177], v24 offset:20480
    v_mfma_f32_16x16x32_bf16 v[64:67], v[184:187], a[208:211], v[64:67]
    s_waitcnt vmcnt(7) lgkmcnt(7)
    ds_read_b64_tr_b16 v[178:179], v19 offset:4096
    v_mfma_f32_16x16x32_bf16 v[52:55], v[188:191], a[216:219], v[52:55]
    ds_read_b64_tr_b16 v[180:181], v26 offset:20480
    v_add_u32 v77, s66, v17
    v_mfma_f32_16x16x32_bf16 v[204:207], v[188:191], a[220:223], v[204:207]
    ds_read_b64_tr_b16 v[182:183], v25 offset:4096
    buffer_load_dwordx4 a[252:255], v38, s[32:35], s82 offen offset:0 sc1
    v_mfma_f32_16x16x32_bf16 v[208:211], v[192:195], a[220:223], v[208:211]
    ds_read_b64_tr_b16 v[184:185], v28 offset:20480
    v_xor_b32 v248, 1024, v77
    v_mfma_f32_16x16x32_bf16 v[56:59], v[192:195], a[216:219], v[56:59]
    s_waitcnt lgkmcnt(7)
    ds_read_b64_tr_b16 v[186:187], v27 offset:4096
    v_add_u32 v249, 65536, v77
    v_mfma_f32_16x16x32_bf16 v[60:63], v[196:199], a[216:219], v[60:63]
    ds_read_b64_tr_b16 v[188:189], v16 offset:16384
    buffer_load_dwordx4 a[0:3], v34, s[32:35], s82 offen offset:2048 sc1
    v_mfma_f32_16x16x32_bf16 v[212:215], v[196:199], a[220:223], v[212:215]
    ds_read_b64_tr_b16 v[190:191], v75 offset:4096
    buffer_load_dwordx4 a[4:7], v38, s[32:35], s82 offen offset:2048 sc1
    v_mfma_f32_16x16x32_bf16 v[216:219], v[200:203], a[220:223], v[216:219]
    ds_read_b64_tr_b16 v[192:193], v19 offset:16384
    v_add_u32 v250, 131072, v77
    v_mfma_f32_16x16x32_bf16 v[64:67], v[200:203], a[216:219], v[64:67]
    s_waitcnt vmcnt(8) lgkmcnt(7)
    ds_read_b64_tr_b16 v[194:195], v13 offset:4096
    v_add_u32 v251, 65536, v248
    v_add_u32 v252, 131072, v248
    v_mfma_f32_16x16x32_bf16 v[52:55], v[40:43], a[224:227], v[52:55]
    ds_read_b64_tr_b16 v[196:197], v25 offset:16384
    s_lshl1_add_u32 s75, s66, 24576
    v_mfma_f32_16x16x32_bf16 v[204:207], v[40:43], a[228:231], v[204:207]
    s_mov_b32 s82, 135168
    ds_read_b64_tr_b16 v[198:199], v14 offset:4096
    buffer_load_dwordx4 a[8:11], v34, s[32:35], s82 offen offset:0 sc1
    v_mfma_f32_16x16x32_bf16 v[208:211], v[176:179], a[228:231], v[208:211]
    ds_read_b64_tr_b16 v[200:201], v27 offset:16384
    v_and_b32 v1, 7, v0
    v_mfma_f32_16x16x32_bf16 v[56:59], v[176:179], a[224:227], v[56:59]
    s_waitcnt lgkmcnt(7)
    ds_read_b64_tr_b16 v[202:203], v15 offset:4096
    v_xor_b32_e64 v1, v32, v1
    v_mfma_f32_16x16x32_bf16 v[60:63], v[180:183], a[224:227], v[60:63]
    ds_read_b64_tr_b16 v[40:41], v75 offset:16384
    v_and_b32_e64 v2, 1, v5
    v_mfma_f32_16x16x32_bf16 v[212:215], v[180:183], a[228:231], v[212:215]
    ds_read_b64_tr_b16 v[42:43], v16 offset:32768
    buffer_load_dwordx4 a[12:15], v38, s[32:35], s82 offen offset:0 sc1
    v_mfma_f32_16x16x32_bf16 v[216:219], v[184:187], a[228:231], v[216:219]
    ds_read_b64_tr_b16 v[176:177], v13 offset:16384
    v_lshl_add_u32 v1, v1, 1, v2
    v_mfma_f32_16x16x32_bf16 v[64:67], v[184:187], a[224:227], v[64:67]
    s_waitcnt vmcnt(8) lgkmcnt(7)
    ds_read_b64_tr_b16 v[178:179], v19 offset:32768
    v_lshl_add_u32 v2, v31, 7, s75
    v_mfma_f32_16x16x32_bf16 v[52:55], v[188:191], a[232:235], v[52:55]
    ds_read_b64_tr_b16 v[180:181], v14 offset:16384
    v_lshl_add_u32 v244, v1, 3, v2
    v_mfma_f32_16x16x32_bf16 v[204:207], v[188:191], a[236:239], v[204:207]
    ds_read_b64_tr_b16 v[182:183], v25 offset:32768
    buffer_load_dwordx4 a[16:19], v34, s[32:35], s82 offen offset:2048 sc1
    v_mfma_f32_16x16x32_bf16 v[208:211], v[192:195], a[236:239], v[208:211]
    ds_read_b64_tr_b16 v[184:185], v15 offset:16384
    v_xor_b32 v245, 32, v244
    v_mfma_f32_16x16x32_bf16 v[56:59], v[192:195], a[232:235], v[56:59]
    s_waitcnt lgkmcnt(7)
    ds_read_b64_tr_b16 v[186:187], v27 offset:32768
    v_xor_b32 v246, 64, v244
    v_mfma_f32_16x16x32_bf16 v[60:63], v[196:199], a[232:235], v[60:63]
    ds_read_b64_tr_b16 v[188:189], v16 offset:45056
    buffer_load_dwordx4 a[20:23], v38, s[32:35], s82 offen offset:2048 sc1
    v_mfma_f32_16x16x32_bf16 v[212:215], v[196:199], a[236:239], v[212:215]
    s_mov_b32 s82, 139264
    ds_read_b64_tr_b16 v[190:191], v18 offset:0
    buffer_load_dwordx4 a[24:27], v34, s[32:35], s82 offen offset:0 sc1
    v_mfma_f32_16x16x32_bf16 v[216:219], v[200:203], a[236:239], v[216:219]
    ds_read_b64_tr_b16 v[192:193], v19 offset:45056
    v_xor_b32 v247, 0x60, v244
    v_mfma_f32_16x16x32_bf16 v[64:67], v[200:203], a[232:235], v[64:67]
    s_waitcnt vmcnt(9) lgkmcnt(7)
    ds_read_b64_tr_b16 v[194:195], v24 offset:0
    v_lshrrev_b32 v1, 3, v0
    v_lshlrev_b32_e64 v2, 4, v1
    v_mfma_f32_16x16x32_bf16 v[52:55], v[40:43], a[240:243], v[52:55]
    ds_read_b64_tr_b16 v[196:197], v25 offset:45056
    v_xor_b32_e64 v2, v2, v17
    v_mfma_f32_16x16x32_bf16 v[204:207], v[40:43], a[244:247], v[204:207]
    ds_read_b64_tr_b16 v[198:199], v26 offset:0
    buffer_load_dwordx4 a[28:31], v38, s[32:35], s82 offen offset:0 sc1
    v_mfma_f32_16x16x32_bf16 v[208:211], v[176:179], a[244:247], v[208:211]
    ds_read_b64_tr_b16 v[200:201], v27 offset:45056
    v_add_u32 v68, s75, v2
    v_mfma_f32_16x16x32_bf16 v[56:59], v[176:179], a[240:243], v[56:59]
    s_waitcnt lgkmcnt(7)
    ds_read_b64_tr_b16 v[202:203], v28 offset:0
    s_lshl_b32 s75, s80, 5
    v_mfma_f32_16x16x32_bf16 v[60:63], v[180:183], a[240:243], v[60:63]
    ds_read_b64_tr_b16 v[40:41], v18 offset:12288
    s_add_u32 s75, s75, s81
    v_mfma_f32_16x16x32_bf16 v[212:215], v[180:183], a[244:247], v[212:215]
    ds_read_b64_tr_b16 v[42:43], v18 offset:24576
    buffer_load_dwordx4 a[32:35], v34, s[32:35], s82 offen offset:2048 sc1
    v_mfma_f32_16x16x32_bf16 v[216:219], v[184:187], a[244:247], v[216:219]
    ds_read_b64_tr_b16 v[176:177], v24 offset:12288
    s_add_u32 s75, s75, s71
    v_mfma_f32_16x16x32_bf16 v[64:67], v[184:187], a[240:243], v[64:67]
    s_waitcnt vmcnt(9) lgkmcnt(7)
    ds_read_b64_tr_b16 v[178:179], v24 offset:24576
    v_lshl_add_u32 v1, v1, 1, s75
    v_mfma_f32_16x16x32_bf16 v[52:55], v[188:191], a[248:251], v[52:55]
    ds_read_b64_tr_b16 v[180:181], v26 offset:12288
    s_lshl_b32 s75, s83, 7
    v_mfma_f32_16x16x32_bf16 v[204:207], v[188:191], a[252:255], v[204:207]
    ds_read_b64_tr_b16 v[182:183], v26 offset:24576
    buffer_load_dwordx4 a[36:39], v38, s[32:35], s82 offen offset:2048 sc1
    v_mfma_f32_16x16x32_bf16 v[208:211], v[192:195], a[252:255], v[208:211]
    ds_read_b64_tr_b16 v[184:185], v28 offset:12288
    v_and_b32 v2, 0x70, v17
    v_mfma_f32_16x16x32_bf16 v[56:59], v[192:195], a[248:251], v[56:59]
    s_waitcnt lgkmcnt(7)
    ds_read_b64_tr_b16 v[186:187], v28 offset:24576
    v_lshl_add_u32 v51, v1, 10, v2
    v_mfma_f32_16x16x32_bf16 v[60:63], v[196:199], a[248:251], v[60:63]
    s_mov_b32 s82, 143360
    ds_read_b64_tr_b16 v[188:189], v16 offset:8192
    buffer_load_dwordx4 a[40:43], v34, s[32:35], s82 offen offset:0 sc1
    v_mfma_f32_16x16x32_bf16 v[212:215], v[196:199], a[252:255], v[212:215]
    ds_read_b64_tr_b16 v[190:191], v16 offset:20480
    buffer_load_dwordx4 a[44:47], v38, s[32:35], s82 offen offset:0 sc1
    v_mfma_f32_16x16x32_bf16 v[216:219], v[200:203], a[252:255], v[216:219]
    ds_read_b64_tr_b16 v[192:193], v19 offset:8192
    s_add_u32 s76, s75, 16384
    v_mfma_f32_16x16x32_bf16 v[64:67], v[200:203], a[248:251], v[64:67]
    s_waitcnt vmcnt(10) lgkmcnt(7)
    ds_read_b64_tr_b16 v[194:195], v19 offset:20480
    v_mfma_f32_16x16x32_bf16 v[52:55], v[40:43], a[0:3], v[52:55]
    ds_read_b64_tr_b16 v[196:197], v25 offset:8192
    v_mfma_f32_16x16x32_bf16 v[204:207], v[40:43], a[4:7], v[204:207]
    ds_read_b64_tr_b16 v[198:199], v25 offset:20480
    v_mfma_f32_16x16x32_bf16 v[208:211], v[176:179], a[4:7], v[208:211]
    ds_read_b64_tr_b16 v[200:201], v27 offset:8192
    v_mfma_f32_16x16x32_bf16 v[56:59], v[176:179], a[0:3], v[56:59]
    s_waitcnt lgkmcnt(7)
    ds_read_b64_tr_b16 v[202:203], v27 offset:20480
    v_mfma_f32_16x16x32_bf16 v[60:63], v[180:183], a[0:3], v[60:63]
    ds_read_b64_tr_b16 v[40:41], v75 offset:8192
    v_mfma_f32_16x16x32_bf16 v[212:215], v[180:183], a[4:7], v[212:215]
    ds_read_b64_tr_b16 v[42:43], v75 offset:20480
    v_mfma_f32_16x16x32_bf16 v[216:219], v[184:187], a[4:7], v[216:219]
    ds_read_b64_tr_b16 v[176:177], v13 offset:8192
    v_mfma_f32_16x16x32_bf16 v[64:67], v[184:187], a[0:3], v[64:67]
L_warm_6:
    s_cbranch_execz L_warm_back
    s_waitcnt vmcnt(8) lgkmcnt(7)
    ds_read_b64_tr_b16 v[178:179], v13 offset:20480
    v_mfma_f32_16x16x32_bf16 v[52:55], v[188:191], a[8:11], v[52:55]
    ds_read_b64_tr_b16 v[180:181], v14 offset:8192
    v_mfma_f32_16x16x32_bf16 v[204:207], v[188:191], a[12:15], v[204:207]
    ds_read_b64_tr_b16 v[182:183], v14 offset:20480
    v_mfma_f32_16x16x32_bf16 v[208:211], v[192:195], a[12:15], v[208:211]
    ds_read_b64_tr_b16 v[184:185], v15 offset:8192
    v_mfma_f32_16x16x32_bf16 v[56:59], v[192:195], a[8:11], v[56:59]
    s_waitcnt lgkmcnt(7)
    ds_read_b64_tr_b16 v[186:187], v15 offset:20480
    v_mfma_f32_16x16x32_bf16 v[60:63], v[196:199], a[8:11], v[60:63]
    ds_read_b64_tr_b16 v[188:189], v16 offset:36864
    v_mfma_f32_16x16x32_bf16 v[212:215], v[196:199], a[12:15], v[212:215]
    ds_read_b64_tr_b16 v[190:191], v16 offset:49152
    v_mfma_f32_16x16x32_bf16 v[216:219], v[200:203], a[12:15], v[216:219]
    ds_read_b64_tr_b16 v[192:193], v19 offset:36864
    v_mfma_f32_16x16x32_bf16 v[64:67], v[200:203], a[8:11], v[64:67]
    s_waitcnt vmcnt(6) lgkmcnt(7)
    ds_read_b64_tr_b16 v[194:195], v19 offset:49152
    v_mfma_f32_16x16x32_bf16 v[52:55], v[40:43], a[16:19], v[52:55]
    ds_read_b64_tr_b16 v[196:197], v25 offset:36864
    v_mfma_f32_16x16x32_bf16 v[204:207], v[40:43], a[20:23], v[204:207]
    ds_read_b64_tr_b16 v[198:199], v25 offset:49152
    v_mfma_f32_16x16x32_bf16 v[208:211], v[176:179], a[20:23], v[208:211]
    ds_read_b64_tr_b16 v[200:201], v27 offset:36864
    v_mfma_f32_16x16x32_bf16 v[56:59], v[176:179], a[16:19], v[56:59]
    s_waitcnt lgkmcnt(7)
    ds_read_b64_tr_b16 v[202:203], v27 offset:49152
    v_mfma_f32_16x16x32_bf16 v[60:63], v[180:183], a[16:19], v[60:63]
    ds_read_b64_tr_b16 v[40:41], v16 offset:53248
    v_mfma_f32_16x16x32_bf16 v[212:215], v[180:183], a[20:23], v[212:215]
    ds_read_b64_tr_b16 v[42:43], v16 offset:57344
    v_mfma_f32_16x16x32_bf16 v[216:219], v[184:187], a[20:23], v[216:219]
    ds_read_b64_tr_b16 v[176:177], v19 offset:53248
    v_mfma_f32_16x16x32_bf16 v[64:67], v[184:187], a[16:19], v[64:67]
    s_waitcnt vmcnt(4) lgkmcnt(7)
    ds_read_b64_tr_b16 v[178:179], v19 offset:57344
    v_mfma_f32_16x16x32_bf16 v[52:55], v[188:191], a[24:27], v[52:55]
    ds_read_b64_tr_b16 v[180:181], v25 offset:53248
    ds_read_b64_tr_b16 v[182:183], v25 offset:57344
    v_mfma_f32_16x16x32_bf16 v[204:207], v[188:191], a[28:31], v[204:207]
    ds_read_b64_tr_b16 v[184:185], v27 offset:53248
    ds_read_b64_tr_b16 v[186:187], v27 offset:57344
    v_mfma_f32_16x16x32_bf16 v[208:211], v[192:195], a[28:31], v[208:211]
    ds_read_b64_tr_b16 v[80:81], v16 offset:61440
    v_mfma_f32_16x16x32_bf16 v[56:59], v[192:195], a[24:27], v[56:59]
    s_waitcnt lgkmcnt(9)
    ds_read_b64_tr_b16 v[82:83], v75 offset:45056
    s_lshr_b32 s73, s2, 3
    s_lshl2_add_u32 s73, s73, s3
    s_cmp_eq_u32 s73, 68
    s_cbranch_scc1 L_wb_25
    s_mov_b64 exec, 1
    buffer_load_dword v6, v73, s[32:35], 0 offen
    s_mov_b64 exec, -1
L_wbback_26:
    v_mfma_f32_16x16x32_bf16 v[60:63], v[196:199], a[24:27], v[60:63]
    ds_read_b64_tr_b16 v[84:85], v19 offset:61440
    ds_read_b64_tr_b16 v[86:87], v13 offset:45056
    v_mfma_f32_16x16x32_bf16 v[212:215], v[196:199], a[28:31], v[212:215]
    ds_read_b64_tr_b16 v[88:89], v25 offset:61440
    ds_read_b64_tr_b16 v[90:91], v14 offset:45056
    v_mfma_f32_16x16x32_bf16 v[216:219], v[200:203], a[28:31], v[216:219]
    ds_read_b64_tr_b16 v[92:93], v27 offset:61440
    v_mfma_f32_16x16x32_bf16 v[64:67], v[200:203], a[24:27], v[64:67]
    s_waitcnt vmcnt(3) lgkmcnt(11)
    ds_read_b64_tr_b16 v[94:95], v15 offset:45056
    v_mfma_f32_16x16x32_bf16 v[52:55], v[40:43], a[32:35], v[52:55]
    v_mfma_f32_16x16x32_bf16 v[204:207], v[40:43], a[36:39], v[204:207]
    v_mfma_f32_16x16x32_bf16 v[208:211], v[176:179], a[36:39], v[208:211]
    v_mfma_f32_16x16x32_bf16 v[56:59], v[176:179], a[32:35], v[56:59]
    s_waitcnt lgkmcnt(8)
    v_mfma_f32_16x16x32_bf16 v[60:63], v[180:183], a[32:35], v[60:63]
    v_mfma_f32_16x16x32_bf16 v[212:215], v[180:183], a[36:39], v[212:215]
    v_mfma_f32_16x16x32_bf16 v[216:219], v[184:187], a[36:39], v[216:219]
    v_mfma_f32_16x16x32_bf16 v[64:67], v[184:187], a[32:35], v[64:67]
    s_waitcnt vmcnt(1) lgkmcnt(0)
    v_mfma_f32_16x16x32_bf16 v[204:207], v[80:83], a[44:47], v[204:207]
    v_mfma_f32_16x16x32_bf16 v[208:211], v[84:87], a[44:47], v[208:211]
    v_mfma_f32_16x16x32_bf16 v[212:215], v[88:91], a[44:47], v[212:215]
    v_mfma_f32_16x16x32_bf16 v[216:219], v[92:95], a[44:47], v[216:219]
    v_mfma_f32_16x16x32_bf16 v[52:55], v[80:83], a[40:43], v[52:55]
    s_nop 3
    ds_write_b128 v77, v[204:207] offset:12288
    v_mfma_f32_16x16x32_bf16 v[56:59], v[84:87], a[40:43], v[56:59]
    ds_write_b128 v249, v[208:211] offset:24576
    v_mfma_f32_16x16x32_bf16 v[60:63], v[88:91], a[40:43], v[60:63]
    ds_write_b128 v249, v[212:215] offset:12288
    v_mfma_f32_16x16x32_bf16 v[64:67], v[92:95], a[40:43], v[64:67]
    ds_write_b128 v250, v[216:219] offset:28672
    s_waitcnt lgkmcnt(0)
    s_barrier
    ds_read_b128 v[204:207], v248 offset:12288
    ds_read_b128 v[208:211], v251 offset:24576
    ds_read_b128 v[212:215], v251 offset:12288
    ds_read_b128 v[216:219], v252 offset:28672
    s_waitcnt lgkmcnt(3)
    v_pk_add_f32 v[52:53], v[52:53], v[204:205]
    v_pk_add_f32 v[54:55], v[54:55], v[206:207]
    v_cvt_pk_bf16_f32 v236, v52, v53
    v_cvt_pk_bf16_f32 v237, v54, v55
    s_waitcnt lgkmcnt(2)
    v_pk_add_f32 v[56:57], v[56:57], v[208:209]
    v_pk_add_f32 v[58:59], v[58:59], v[210:211]
    v_cvt_pk_bf16_f32 v238, v56, v57
    v_cvt_pk_bf16_f32 v239, v58, v59
    s_waitcnt lgkmcnt(1)
    v_pk_add_f32 v[60:61], v[60:61], v[212:213]
    v_pk_add_f32 v[62:63], v[62:63], v[214:215]
    v_cvt_pk_bf16_f32 v240, v60, v61
    v_cvt_pk_bf16_f32 v241, v62, v63
    s_waitcnt lgkmcnt(0)
    v_pk_add_f32 v[64:65], v[64:65], v[216:217]
    v_pk_add_f32 v[66:67], v[66:67], v[218:219]
    v_cvt_pk_bf16_f32 v242, v64, v65
    v_cvt_pk_bf16_f32 v243, v66, v67
    ds_write_b64 v244, v[236:237]
    ds_write_b64 v245, v[238:239]
    ds_write_b64 v246, v[240:241]
    ds_write_b64 v247, v[242:243]
    ds_read_b128 v[204:207], v68 offset:0
    ds_read_b128 v[208:211], v68 offset:1024
    s_waitcnt lgkmcnt(1)
    buffer_store_dwordx4 v[204:207], v51, s[24:27], s75 offen sc1
    s_waitcnt lgkmcnt(0)
    buffer_store_dwordx4 v[208:211], v51, s[24:27], s76 offen sc1
L_end:
    s_endpgm
L_wb_25:
    buffer_wbl2 sc1
    s_branch L_wbback_26
L_poll_23:
    s_mov_b32 s79, 0
    s_cmp_lg_u32 s60, 0
    s_cbranch_scc1 L_poll_23_s
L_poll_23_l:
    buffer_load_dword v10, v73, s[32:35], 0 offen offset:2048 sc1
    s_add_u32 s79, s79, 1
    s_waitcnt vmcnt(0)
    v_cmp_ne_u32 vcc, s78, v10
    s_nop 0
    s_cbranch_vccz L_pollback_24
    s_cmp_lt_u32 s79, 200
    s_cbranch_scc1 L_poll_23_l
    s_branch L_poll_23_t
L_poll_19:
    s_mov_b32 s79, 0
    s_cmp_lg_u32 s60, 0
    s_cbranch_scc1 L_poll_19_s
L_poll_19_l:
    buffer_load_dword v10, v73, s[32:35], 0 offen offset:1536 sc1
    s_add_u32 s79, s79, 1
    s_waitcnt vmcnt(0)
    v_cmp_ne_u32 vcc, s78, v10
    s_nop 0
    s_cbranch_vccz L_pollback_20
    s_cmp_lt_u32 s79, 200
    s_cbranch_scc1 L_poll_19_l
    s_branch L_poll_19_t
L_poll_15:
    s_mov_b32 s79, 0
    s_cmp_lg_u32 s60, 0
    s_cbranch_scc1 L_poll_15_s
L_poll_15_l:
    buffer_load_dword v10, v73, s[32:35], 0 offen offset:1024 sc1
    s_add_u32 s79, s79, 1
    s_waitcnt vmcnt(0)
    v_cmp_ne_u32 vcc, s78, v10
    s_nop 0
    s_cbranch_vccz L_pollback_16
    s_cmp_lt_u32 s79, 200
    s_cbranch_scc1 L_poll_15_l
    s_branch L_poll_15_t
L_regpoll_3:
    s_mov_b32 s79, 0
    s_lshl_b32 s56, s70, 4
L_regpoll_3_l:
    s_add_u32 s79, s79, 1
    s_cmp_gt_u32 s79, SPIN_MAX
    s_cbranch_scc1 L_end
    s_sleep 2
    buffer_load_dword v85, off, s[28:31], s56 sc1
    s_waitcnt vmcnt(0)
    v_cmp_eq_u32 vcc, 0, v85
    s_nop 0
    s_cbranch_vccnz L_regpoll_3_l
    s_branch L_regok_4
L_slowsig_5:
    s_waitcnt vmcnt(0)
    buffer_wbl2 sc1
    s_waitcnt vmcnt(0)
    s_mov_b64 exec, 1
    buffer_store_dword v74, v70, s[32:35], 0 offen offset:2560 sc1
    s_mov_b64 exec, -1
    s_waitcnt vmcnt(0)
    s_branch L_sigback_6
L_poll_7_t:
    s_mov_b32 s60, 1
    buffer_wbl2 sc1
    s_waitcnt vmcnt(0)
    s_mov_b64 exec, 1
    buffer_store_dword v74, v70, s[32:35], 0 offen offset:2560 sc1
    s_mov_b64 exec, -1
L_poll_7_s:
    s_add_u32 s56, s72, 667648
    v_subrev_u32 v12, s56, v71
    v_lshrrev_b32 v12, 7, v12
    v_lshlrev_b32 v12, 6, v12
    v_sub_u32 v12, v71, v12
L_poll_7_m:
    buffer_load_dword v10, v71, s[32:35], 0 offen offset:0 sc1
    buffer_load_dword v11, v12, s[32:35], 0 offen offset:2560 sc1
    s_add_u32 s79, s79, 1
    s_cmp_gt_u32 s79, SPIN_MAX
    s_cbranch_scc1 L_end
    s_sleep 2
    s_waitcnt vmcnt(0)
    v_cmp_ne_u32 vcc, s78, v10
    v_cmp_eq_u32 s[56:57], 0, v11
    s_nop 0
    s_and_b64 s[56:57], s[56:57], vcc
    s_cbranch_scc1 L_poll_7_m
    buffer_inv sc1
    s_waitcnt vmcnt(0)
    s_branch L_pollback_8
L_slowsig_9:
    s_waitcnt vmcnt(0)
    buffer_wbl2 sc1
    s_waitcnt vmcnt(0)
    s_mov_b64 exec, 2
    buffer_store_dword v74, v70, s[32:35], 0 offen offset:2560 sc1
    s_mov_b64 exec, -1
    s_waitcnt vmcnt(0)
    s_branch L_sigback_10
L_poll_11_t:
    s_mov_b32 s60, 1
    buffer_wbl2 sc1
    s_waitcnt vmcnt(0)
    s_mov_b64 exec, 3
    buffer_store_dword v74, v70, s[32:35], 0 offen offset:2560 sc1
    s_mov_b64 exec, -1
L_poll_11_s:
    s_add_u32 s56, s72, 667648
    v_subrev_u32 v12, s56, v72
    v_lshrrev_b32 v12, 7, v12
    v_lshlrev_b32 v12, 6, v12
    v_sub_u32 v12, v72, v12
L_poll_11_m:
    buffer_load_dword v10, v72, s[32:35], 0 offen offset:512 sc1
    buffer_load_dword v11, v12, s[32:35], 0 offen offset:2816 sc1
    s_add_u32 s79, s79, 1
    s_cmp_gt_u32 s79, SPIN_MAX
    s_cbranch_scc1 L_end
    s_sleep 2
    s_waitcnt vmcnt(0)
    v_cmp_ne_u32 vcc, s78, v10
    v_cmp_eq_u32 s[56:57], 0, v11
    s_nop 0
    s_and_b64 s[56:57], s[56:57], vcc
    s_cbranch_scc1 L_poll_11_m
    buffer_inv sc1
    s_waitcnt vmcnt(0)
    s_branch L_pollback_12
L_slowsig_13:
    s_waitcnt vmcnt(0)
    buffer_wbl2 sc1
    s_waitcnt vmcnt(0)
    s_mov_b64 exec, 4
    buffer_store_dword v74, v70, s[32:35], 0 offen offset:2560 sc1
    s_mov_b64 exec, -1
    s_waitcnt vmcnt(0)
    s_branch L_sigback_14
L_poll_15_t:
    s_mov_b32 s60, 1
    buffer_wbl2 sc1
    s_waitcnt vmcnt(0)
    s_mov_b64 exec, 7
    buffer_store_dword v74, v70, s[32:35], 0 offen offset:2560 sc1
    s_mov_b64 exec, -1
L_poll_15_s:
    s_add_u32 s56, s72, 667648
    v_subrev_u32 v12, s56, v73
    v_lshrrev_b32 v12, 7, v12
    v_lshlrev_b32 v12, 6, v12
    v_sub_u32 v12, v73, v12
L_poll_15_m:
    buffer_load_dword v10, v73, s[32:35], 0 offen offset:1024 sc1
    buffer_load_dword v11, v12, s[32:35], 0 offen offset:3072 sc1
    s_add_u32 s79, s79, 1
    s_cmp_gt_u32 s79, SPIN_MAX
    s_cbranch_scc1 L_end
    s_sleep 2
    s_waitcnt vmcnt(0)
    v_cmp_ne_u32 vcc, s78, v10
    v_cmp_eq_u32 s[56:57], 0, v11
    s_nop 0
    s_and_b64 s[56:57], s[56:57], vcc
    s_cbranch_scc1 L_poll_15_m
    buffer_inv sc1
    s_waitcnt vmcnt(0)
    s_branch L_pollback_16
L_slowsig_17:
    s_waitcnt vmcnt(0)
    buffer_wbl2 sc1
    s_waitcnt vmcnt(0)
    s_mov_b64 exec, 8
    buffer_store_dword v74, v70, s[32:35], 0 offen offset:2560 sc1
    s_mov_b64 exec, -1
    s_waitcnt vmcnt(0)
    s_branch L_sigback_18
L_poll_19_t:
    s_mov_b32 s60, 1
    buffer_wbl2 sc1
    s_waitcnt vmcnt(0)
    s_mov_b64 exec, 15
    buffer_store_dword v74, v70, s[32:35], 0 offen offset:2560 sc1
    s_mov_b64 exec, -1
L_poll_19_s:
    s_add_u32 s56, s72, 667648
    v_subrev_u32 v12, s56, v73
    v_lshrrev_b32 v12, 7, v12
    v_lshlrev_b32 v12, 6, v12
    v_sub_u32 v12, v73, v12
L_poll_19_m:
    buffer_load_dword v10, v73, s[32:35], 0 offen offset:1536 sc1
    buffer_load_dword v11, v12, s[32:35], 0 offen offset:3328 sc1
    s_add_u32 s79, s79, 1
    s_cmp_gt_u32 s79, SPIN_MAX
    s_cbranch_scc1 L_end
    s_sleep 2
    s_waitcnt vmcnt(0)
    v_cmp_ne_u32 vcc, s78, v10
    v_cmp_eq_u32 s[56:57], 0, v11
    s_nop 0
    s_and_b64 s[56:57], s[56:57], vcc
    s_cbranch_scc1 L_poll_19_m
    buffer_inv sc1
    s_waitcnt vmcnt(0)
    s_branch L_pollback_20
L_slowsig_21:
    s_waitcnt vmcnt(0)
    buffer_wbl2 sc1
    s_waitcnt vmcnt(0)
    s_mov_b64 exec, 16
    buffer_store_dword v74, v70, s[32:35], 0 offen offset:2560 sc1
    s_mov_b64 exec, -1
    s_waitcnt vmcnt(0)
    s_branch L_sigback_22
L_poll_23_t:
    s_mov_b32 s60, 1
    buffer_wbl2 sc1
    s_waitcnt vmcnt(0)
    s_mov_b64 exec, 31
    buffer_store_dword v74, v70, s[32:35], 0 offen offset:2560 sc1
    s_mov_b64 exec, -1
L_poll_23_s:
    s_add_u32 s56, s72, 667648
    v_subrev_u32 v12, s56, v73
    v_lshrrev_b32 v12, 7, v12
    v_lshlrev_b32 v12, 6, v12
    v_sub_u32 v12, v73, v12
L_poll_23_m:
    buffer_load_dword v10, v73, s[32:35], 0 offen offset:2048 sc1
    buffer_load_dword v11, v12, s[32:35], 0 offen offset:3584 sc1
    s_add_u32 s79, s79, 1
    s_cmp_gt_u32 s79, SPIN_MAX
    s_cbranch_scc1 L_end
    s_sleep 2
    s_waitcnt vmcnt(0)
    v_cmp_ne_u32 vcc, s78, v10
    v_cmp_eq_u32 s[56:57], 0, v11
    s_nop 0
    s_and_b64 s[56:57], s[56:57], vcc
    s_cbranch_scc1 L_poll_23_m
    buffer_inv sc1
    s_waitcnt vmcnt(0)
    s_branch L_pollback_24
L_code_end:
    s_endpgm
.section .rodata,"a"
.p2align 6
.amdhsa_kernel sequential_preLN__sliding_local_dilated__geglu_ffn__prompt_kernel
  .amdhsa_next_free_vgpr 512
  .amdhsa_next_free_sgpr 102
  .amdhsa_accum_offset 256
  .amdhsa_group_segment_fixed_size 0
  .amdhsa_kernarg_size 80
  .amdhsa_user_sgpr_count 2
  .amdhsa_user_sgpr_kernarg_segment_ptr 1
  .amdhsa_system_sgpr_workgroup_id_x 1
  .amdhsa_float_denorm_mode_32 3
.end_amdhsa_kernel
```
